```python
import torch

def _softmax(x, axis=-1):
    return torch.softmax(x, dim=axis)
def _gelu(x):
    return torch.nn.functional.gelu(x, approximate="tanh")
def _silu(x):
    return torch.nn.functional.silu(x)
def _sigmoid(x):
    return torch.sigmoid(x)
def _layernorm(x, axis=-1, eps=1e-5):
    m = x.mean(dim=axis, keepdim=True)
    v = x.var(dim=axis, keepdim=True, unbiased=False)
    return (x - m) / torch.sqrt(v + eps)
def _scatter_add(tgt, idx, src, axis=0):
    return tgt.clone().index_add_(axis, idx, src)
def _segment_sum(src, seg, n):
    out = torch.zeros((n,) + src.shape[1:], dtype=src.dtype)
    return out.index_add_(0, seg, src)
def _pad(x, pw):
    flat = tuple(v for pair in reversed(pw) for v in pair)
    return torch.nn.functional.pad(x, flat)

kernel_name = 'concat_heads__gqa_block_cached__mha_block_cached__near_ridge'

def setup_inputs():

    _w = (lambda a: (lambda t: t.to(torch.bfloat16) if t.is_floating_point() else t)(torch.as_tensor(a)))
    def _A_setup():
        B, Sq, D = 32, 32, 640
        Hq, Hkv, Sk, Dh = 32, 32, 32, 128
        assert Hq % Hkv == 0, (Hq, Hkv)
        return {
            "x": _w((lambda *s: torch.randn(*s, dtype=torch.bfloat16) * 0.8)(B, Sq, D)),
            "k_cache": _w((lambda *s: torch.randn(*s, dtype=torch.bfloat16) * 0.8)(B, Hkv, Sk, Dh)),
            "v_cache": _w((lambda *s: torch.randn(*s, dtype=torch.bfloat16) * 0.05)(B, Hkv, Sk, Dh)),
            "wq": _w((lambda *s: torch.randn(*s, dtype=torch.bfloat16) * 0.8)(D, Hq * Dh) * (D ** -0.5)),
            "wo": _w((lambda *s: torch.randn(*s, dtype=torch.bfloat16) * 0.05)(Hq * Dh, D) * ((Hq * Dh) ** -0.5)),
        }
    _A_in = _A_setup()

    def _B_setup():
        B, Sq, D = 32, 32, 640
        H, Sk, Dh = 32, 32, 128
        return {
            "x": _w((lambda *s: torch.randn(*s, dtype=torch.bfloat16) * 0.8)(B, Sq, D)),
            "k_cache": _w((lambda *s: torch.randn(*s, dtype=torch.bfloat16) * 0.8)(B, H, Sk, Dh)),
            "v_cache": _w((lambda *s: torch.randn(*s, dtype=torch.bfloat16) * 0.05)(B, H, Sk, Dh)),
            "wq": _w((lambda *s: torch.randn(*s, dtype=torch.bfloat16) * 0.8)(D, H * Dh) * (D ** -0.5)),
            "wo": _w((lambda *s: torch.randn(*s, dtype=torch.bfloat16) * 0.05)(H * Dh, D) * ((H * Dh) ** -0.5)),
        }
    _B_in = _B_setup()

    return {
        "A_x": _A_in["x"],
        "A_k_cache": _A_in["k_cache"],
        "A_v_cache": _A_in["v_cache"],
        "A_wq": _A_in["wq"],
        "A_wo": _A_in["wo"],
        "B_x": _B_in["x"],
        "B_k_cache": _B_in["k_cache"],
        "B_v_cache": _B_in["v_cache"],
        "B_wq": _B_in["wq"],
        "B_wo": _B_in["wo"],
    }

def reference(A_x, A_k_cache, A_v_cache, A_wq, A_wo, B_x, B_k_cache, B_v_cache, B_wq, B_wo):
    def _A_ref(x, k_cache, v_cache, wq, wo):
        B, Sq, D = x.shape
        Hq, Dh = 32, 128
        Hkv = k_cache.shape[1]
        rep = Hq // Hkv
        q = (lambda x, *d: x.permute(*d))((x @ wq).reshape(B, Sq, Hq, Dh), 0, 2, 1, 3)
        k = (lambda x, n, axis: torch.repeat_interleave(x, n, dim=axis))(k_cache, rep, axis=1)
        v = (lambda x, n, axis: torch.repeat_interleave(x, n, dim=axis))(v_cache, rep, axis=1)
        scores = torch.einsum("bhqd,bhkd->bhqk", q, k) * (Dh ** -0.5)
        p = _softmax(scores, axis=-1)
        o = torch.einsum("bhqk,bhkd->bhqd", p, v)
        return (lambda x, *d: x.permute(*d))(o, 0, 2, 1, 3).reshape(B, Sq, Hq * Dh) @ wo

    def _B_ref(x, k_cache, v_cache, wq, wo):
        B, Sq, D = x.shape
        H, Dh = 32, 128
        q = (lambda x, *d: x.permute(*d))((x @ wq).reshape(B, Sq, H, Dh), 0, 2, 1, 3)
        scores = torch.einsum("bhqd,bhkd->bhqk", q, k_cache) * (Dh ** -0.5)
        p = _softmax(scores, axis=-1)
        o = torch.einsum("bhqk,bhkd->bhqd", p, v_cache)
        return (lambda x, *d: x.permute(*d))(o, 0, 2, 1, 3).reshape(B, Sq, H * Dh) @ wo

    a = _A_ref(A_x, A_k_cache, A_v_cache, A_wq, A_wo)
    b = _B_ref(B_x, B_k_cache, B_v_cache, B_wq, B_wo)
    return torch.concatenate([a, b], axis=-1)
```

```asm
; @launch grid=(256,1,1) block=(256,1,1) lds=163840
.amdgcn_target "amdgcn-amd-amdhsa--gfx950"
.text
.globl concat_heads__gqa_block_cached__mha_block_cached__near_ridge_kernel
.p2align 8
.type concat_heads__gqa_block_cached__mha_block_cached__near_ridge_kernel,@function
concat_heads__gqa_block_cached__mha_block_cached__near_ridge_kernel:
    s_cmp_ge_u32 s2, 256
    s_cbranch_scc1 L_end1
    s_load_dwordx16 s[36:51], s[0:1], 0
    s_load_dwordx4 s[52:55], s[0:1], 64
    s_load_dwordx2 s[28:29], s[0:1], 96
    v_lshrrev_b32 v1, 6, v0
    v_and_b32 v0, 63, v0
    v_readfirstlane_b32 s32, v1
    s_getpc_b64 s[90:91]
L_pc:
    s_sub_u32 s90, s90, L_pc-concat_heads__gqa_block_cached__mha_block_cached__near_ridge_kernel
    s_subb_u32 s91, s91, 0
    s_lshl_b32 s92, s32, 6
    v_add_u32 v70, s92, v0
    v_mul_u32_u24 v70, 128, v70
    v_add_u32 v71, 0, v70
    v_min_u32 v71, L_end1-concat_heads__gqa_block_cached__mha_block_cached__near_ridge_kernel, v71
    v_mov_b32 v67, s91
    v_add_co_u32 v66, vcc, s90, v71
    v_addc_co_u32 v67, vcc, 0, v67, vcc
    global_load_dword v68, v[66:67], off
    s_and_b32 s33, s2, 7
    s_lshr_b32 s33, s33, 2
    s_and_b32 s34, s2, 3
    s_lshl_b32 s34, s34, 1
    s_bfe_u32 s79, s2, 0x10003
    s_add_u32 s34, s34, s79
    s_lshr_b32 s35, s2, 4
    s_mul_i32 s81, s35, 10
    s_lshr_b32 s81, s81, 4
    s_mul_i32 s6, s35, 5
    s_lshr_b32 s6, s6, 4
    s_mul_i32 s6, s6, 2
    s_and_b32 s5, s35, 3
    s_and_b32 s7, s34, 1
    s_mul_i32 s7, s7, 5
    s_add_u32 s7, s7, s6
    s_sub_u32 s79, s7, 10
    s_cmp_ge_u32 s7, 10
    s_cselect_b32 s7, s79, s7
    v_lshrrev_b32 v16, 4, v0
    v_and_b32 v17, 15, v0
    v_lshrrev_b32 v18, 3, v0
    v_and_b32 v19, 7, v0
    v_lshrrev_b32 v20, 2, v17
    v_xor_b32 v20, v20, v16
    v_lshlrev_b32 v20, 6, v20
    v_and_b32 v21, 3, v17
    v_lshl_add_u32 v20, v21, 4, v20
    v_lshl_add_u32 v2, v16, 13, v20
    v_add_u32 v3, 31744, v2
    v_add_u32 v4, 63488, v2
    v_add_u32 v5, 95232, v2
    v_lshl_add_u32 v24, v16, 8, v20
    v_xor_b32 v21, v17, v16
    v_lshlrev_b32 v21, 4, v21
    v_lshl_add_u32 v25, v16, 8, v21
    v_xor_b32 v26, 64, v25
    v_xor_b32 v27, 128, v25
    v_xor_b32 v28, 192, v25
    s_mul_i32 s79, s32, 20480
    v_lshrrev_b32 v20, 1, v18
    v_xor_b32 v20, v20, v19
    v_lshlrev_b32 v20, 4, v20
    v_mul_u32_u24 v21, 1280, v18
    v_add_u32 v21, s79, v21
    v_add_u32 v6, v21, v20
    v_xor_b32 v20, 64, v20
    v_add_u32 v7, v21, v20
    v_add_u32 v7, 9216, v7
    s_mul_i32 s64, s32, 24576
    s_lshl_b32 s65, s32, 13
    s_add_u32 s65, s65, 131072
    s_lshl_b32 s66, s32, 11
    s_add_u32 s66, s66, 98304
    s_lshl_b32 s67, s34, 2
    s_add_u32 s67, s67, s32
    s_lshl_b32 s58, s67, 8
    s_add_u32 s57, s58, 5242880
    s_lshl_b32 s79, s7, 19
    s_add_u32 s56, s58, s79
    s_mul_i32 s61, s35, 81920
    s_add_u32 s60, s61, 1280
    s_lshl_b32 s79, s7, 7
    s_add_u32 s59, s61, s79
    s_lshl_b32 s62, s35, 6
    s_add_u32 s62, s62, s67
    s_lshl_b32 s62, s62, 13
    s_add_u32 s63, s62, 262144
    s_waitcnt lgkmcnt(0)
    s_cmp_eq_u32 s33, 0
    s_cselect_b32 s12, s36, s46
    s_cselect_b32 s13, s37, s47
    s_mov_b32 s14, 1310720
    s_mov_b32 s15, 0x20000
    s_cselect_b32 s16, s38, s48
    s_cselect_b32 s17, s39, s49
    s_mov_b32 s18, 8388608
    s_mov_b32 s19, 0x20000
    s_cselect_b32 s20, s40, s50
    s_cselect_b32 s21, s41, s51
    s_mov_b32 s22, 8388608
    s_mov_b32 s23, 0x20000
    s_cselect_b32 s8, s42, s52
    s_cselect_b32 s9, s43, s53
    s_mov_b32 s10, 5242880
    s_mov_b32 s11, 0x20000
    s_cselect_b32 s24, s44, s54
    s_cselect_b32 s25, s45, s55
    s_mov_b32 s26, 5242880
    s_mov_b32 s27, 0x20000
    s_mov_b32 s30, 268435456
    s_mov_b32 s31, 0x20000
    s_add_u32 m0, s66, 0
    s_nop 0
    buffer_load_dwordx4 v6, s[12:15], s59 offen offset:0  lds
    buffer_load_dwordx4 v7, s[12:15], s59 offen offset:1024  lds
    s_add_u32 s59, s59, 128
    s_cmp_eq_u32 s59, s60
    s_cselect_b32 s59, s61, s59
    s_add_u32 m0, s64, 0
    s_nop 0
    buffer_load_dwordx4 v2, s[8:11], s56 offen offset:0  lds
    buffer_load_dwordx4 v3, s[8:11], s56 offen offset:1024  lds
    buffer_load_dwordx4 v4, s[8:11], s56 offen offset:2048  lds
    buffer_load_dwordx4 v5, s[8:11], s56 offen offset:3072  lds
    s_add_u32 s56, s56, 131072
    s_add_u32 m0, s64, 4096
    s_nop 0
    buffer_load_dwordx4 v2, s[8:11], s56 offen offset:0  lds
    buffer_load_dwordx4 v3, s[8:11], s56 offen offset:1024  lds
    buffer_load_dwordx4 v4, s[8:11], s56 offen offset:2048  lds
    buffer_load_dwordx4 v5, s[8:11], s56 offen offset:3072  lds
    s_add_u32 s56, s56, 131072
    s_add_u32 m0, s64, 8192
    s_nop 0
    buffer_load_dwordx4 v2, s[8:11], s56 offen offset:0  lds
    buffer_load_dwordx4 v3, s[8:11], s56 offen offset:1024  lds
    buffer_load_dwordx4 v4, s[8:11], s56 offen offset:2048  lds
    buffer_load_dwordx4 v5, s[8:11], s56 offen offset:3072  lds
    s_add_u32 s56, s56, 131072
    s_load_dwordx4 s[36:39], s[0:1], 80
    s_lshl_b32 s44, s33, 4
    s_add_u32 s44, s44, s35
    s_lshl_b32 s49, s44, 12
    s_add_u32 s49, s49, 33554432
    s_lshl_b32 s50, s32, 7
    s_add_u32 s50, s50, s49
    s_lshl_b32 s51, s34, 9
    s_add_u32 s51, s51, s50
    s_lshl_b32 s52, s34, 2
    v_and_b32 v16, 31, v0
    v_lshlrev_b32 v16, 2, v16
    v_mov_b32 v17, 0
    buffer_store_dword v17, v16, s[28:31], s51 offen offset:0 sc1
    v_lshrrev_b32 v20, 5, v0
    v_bfe_u32 v21, v0, 4, 1
    v_bfe_u32 v22, v0, 2, 2
    v_and_b32 v23, 3, v0
    v_lshl_add_u32 v8, v20, 3, v22
    v_lshlrev_b32 v8, 8, v8
    v_lshl_add_u32 v8, v22, 6, v8
    v_lshl_add_u32 v8, v21, 5, v8
    v_and_b32 v16, 1, v23
    v_lshrrev_b32 v17, 1, v23
    v_lshl_add_u32 v16, v16, 1, v17
    v_lshl_add_u32 v8, v16, 3, v8
    v_add_u32 v8, s64, v8
    v_xor_b32 v9, 64, v8
    v_xor_b32 v10, 128, v8
    v_xor_b32 v11, 192, v8
    v_lshl_add_u32 v29, v20, 2, v22
    v_lshlrev_b32 v29, 8, v29
    v_lshl_add_u32 v29, v22, 6, v29
    v_lshl_add_u32 v29, v21, 5, v29
    v_lshl_add_u32 v29, v23, 3, v29
    v_add_u32 v29, s65, v29
    v_lshl_add_u32 v31, v20, 2, v22
    v_lshlrev_b32 v31, 7, v31
    v_lshrrev_b32 v16, 1, v22
    v_lshl_add_u32 v31, v16, 6, v31
    v_lshl_add_u32 v31, v21, 5, v31
    v_lshl_add_u32 v31, v23, 3, v31
    v_add_u32 v31, s64, v31
    v_and_b32 v16, 31, v0
    v_bfe_u32 v17, v0, 1, 3
    v_xor_b32 v17, v17, v20
    v_lshlrev_b32 v17, 4, v17
    v_lshl_add_u32 v12, v16, 7, v17
    v_add_u32 v12, 98304, v12
    v_xor_b32 v13, 32, v12
    v_xor_b32 v14, 64, v12
    v_xor_b32 v15, 96, v12
    v_and_b32 v17, 15, v0
    v_xor_b32 v17, v17, v20
    v_lshlrev_b32 v17, 4, v17
    v_lshl_add_u32 v30, v16, 8, v17
    v_add_u32 v30, s65, v30
    s_lshl_b32 s79, s34, 2
    s_add_u32 s3, s32, 0
    s_and_b32 s3, s3, 3
    s_add_u32 s3, s3, s79
    s_mul_i32 s68, s3, 163840
    s_add_u32 s3, s32, 1
    s_and_b32 s3, s3, 3
    s_add_u32 s3, s3, s79
    s_mul_i32 s69, s3, 163840
    s_add_u32 s3, s32, 2
    s_and_b32 s3, s3, 3
    s_add_u32 s3, s3, s79
    s_mul_i32 s70, s3, 163840
    s_add_u32 s3, s32, 3
    s_and_b32 s3, s3, 3
    s_add_u32 s3, s3, s79
    s_mul_i32 s71, s3, 163840
    s_lshr_b32 s3, s32, 1
    s_add_u32 s74, s3, 8
    s_add_u32 s73, s32, 4
    s_mov_b32 s72, s32
    s_lshl_b32 s4, s33, 4
    s_add_u32 s4, s4, s35
    s_mul_i32 s4, s4, 10
    s_add_u32 s72, s72, s81
    s_sub_u32 s3, s72, 10
    s_cmp_ge_u32 s72, 10
    s_cselect_b32 s72, s3, s72
    s_add_u32 s3, s4, s72
    s_lshl_b32 s3, s3, 3
    s_add_u32 s3, s3, s34
    s_lshl_b32 s76, s3, 13
    s_lshl_b32 s72, s72, 7
    s_add_u32 s73, s73, s81
    s_sub_u32 s3, s73, 10
    s_cmp_ge_u32 s73, 10
    s_cselect_b32 s73, s3, s73
    s_add_u32 s3, s4, s73
    s_lshl_b32 s3, s3, 3
    s_add_u32 s3, s3, s34
    s_lshl_b32 s77, s3, 13
    s_lshl_b32 s73, s73, 7
    s_add_u32 s74, s74, s81
    s_sub_u32 s3, s74, 10
    s_cmp_ge_u32 s74, 10
    s_cselect_b32 s74, s3, s74
    s_add_u32 s3, s4, s74
    s_lshl_b32 s3, s3, 3
    s_add_u32 s3, s3, s34
    s_lshl_b32 s78, s3, 13
    s_lshl_b32 s74, s74, 7
    s_add_u32 s3, s32, 1
    s_and_b32 s3, s3, 3
    s_sub_u32 s3, s3, s32
    s_lshl_b32 s40, s3, 13
    s_add_u32 s3, s32, 2
    s_and_b32 s3, s3, 3
    s_sub_u32 s3, s3, s32
    s_lshl_b32 s41, s3, 13
    s_add_u32 s3, s32, 3
    s_and_b32 s3, s3, 3
    s_sub_u32 s3, s3, s32
    s_lshl_b32 s42, s3, 13
    s_mov_b32 s80, 0x3e0293ee
    s_waitcnt vmcnt(9)
    s_barrier
    ds_read_b128 v[80:83], v12 offset:0
    ds_read_b128 v[84:87], v12 offset:4096
    ds_read_b64_tr_b16 v[96:97], v8 offset:0
    ds_read_b64_tr_b16 v[98:99], v8 offset:1024
    ds_read_b64_tr_b16 v[100:101], v9 offset:0
    ds_read_b64_tr_b16 v[102:103], v9 offset:1024
    ds_read_b64_tr_b16 v[104:105], v10 offset:0
    ds_read_b64_tr_b16 v[106:107], v10 offset:1024
    ds_read_b64_tr_b16 v[108:109], v11 offset:0
    ds_read_b64_tr_b16 v[110:111], v11 offset:1024
    s_waitcnt lgkmcnt(0)
    v_mfma_f32_32x32x16_bf16 v[128:143], v[96:99], v[80:83], 0
    s_add_u32 m0, s64, 12288
    s_nop 0
    buffer_load_dwordx4 v2, s[8:11], s56 offen offset:0  lds
    v_mfma_f32_32x32x16_bf16 v[192:207], v[96:99], v[84:87], 0
    buffer_load_dwordx4 v3, s[8:11], s56 offen offset:1024  lds
    s_waitcnt vmcnt(7)
    ds_read_b128 v[88:91], v13 offset:0
    ds_read_b128 v[92:95], v13 offset:4096
    v_mfma_f32_32x32x16_bf16 v[144:159], v[100:103], v[80:83], 0
    buffer_load_dwordx4 v4, s[8:11], s56 offen offset:2048  lds
    ds_read_b64_tr_b16 v[112:113], v8 offset:4096
    ds_read_b64_tr_b16 v[114:115], v8 offset:5120
    v_mfma_f32_32x32x16_bf16 v[208:223], v[100:103], v[84:87], 0
    buffer_load_dwordx4 v5, s[8:11], s56 offen offset:3072  lds
    s_add_u32 s56, s56, 131072
    s_cmp_eq_u32 s56, s57
    s_cselect_b32 s56, s58, s56
    ds_read_b64_tr_b16 v[116:117], v9 offset:4096
    ds_read_b64_tr_b16 v[118:119], v9 offset:5120
    v_mfma_f32_32x32x16_bf16 v[160:175], v[104:107], v[80:83], 0
    ds_read_b64_tr_b16 v[120:121], v10 offset:4096
    ds_read_b64_tr_b16 v[122:123], v10 offset:5120
    s_add_u32 m0, s66, 8192
    s_nop 0
    buffer_load_dwordx4 v6, s[12:15], s59 offen offset:0  lds
    buffer_load_dwordx4 v7, s[12:15], s59 offen offset:1024  lds
    s_add_u32 s59, s59, 128
    s_cmp_eq_u32 s59, s60
    s_cselect_b32 s59, s61, s59
    v_mfma_f32_32x32x16_bf16 v[224:239], v[104:107], v[84:87], 0
    ds_read_b64_tr_b16 v[124:125], v11 offset:4096
    ds_read_b64_tr_b16 v[126:127], v11 offset:5120
    v_mfma_f32_32x32x16_bf16 v[176:191], v[108:111], v[80:83], 0
    s_add_u32 m0, s64, 16384
    s_nop 0
    buffer_load_dwordx4 v2, s[8:11], s56 offen offset:0  lds
    buffer_load_dwordx4 v3, s[8:11], s56 offen offset:1024  lds
    buffer_load_dwordx4 v4, s[8:11], s56 offen offset:2048  lds
    buffer_load_dwordx4 v5, s[8:11], s56 offen offset:3072  lds
    s_add_u32 s56, s56, 131072
    v_mfma_f32_32x32x16_bf16 v[240:255], v[108:111], v[84:87], 0
    s_add_u32 m0, s64, 20480
    s_nop 0
    buffer_load_dwordx4 v2, s[8:11], s56 offen offset:0  lds
    buffer_load_dwordx4 v3, s[8:11], s56 offen offset:1024  lds
    buffer_load_dwordx4 v4, s[8:11], s56 offen offset:2048  lds
    buffer_load_dwordx4 v5, s[8:11], s56 offen offset:3072  lds
    s_add_u32 s56, s56, 131072
    s_waitcnt lgkmcnt(0)
    v_mfma_f32_32x32x16_bf16 v[128:143], v[112:115], v[88:91], v[128:143]
    s_add_u32 m0, s64, 0
    s_nop 0
    buffer_load_dwordx4 v2, s[8:11], s56 offen offset:0  lds
    v_mfma_f32_32x32x16_bf16 v[192:207], v[112:115], v[92:95], v[192:207]
    buffer_load_dwordx4 v3, s[8:11], s56 offen offset:1024  lds
    s_waitcnt vmcnt(17)
    ds_read_b128 v[80:83], v14 offset:0
    ds_read_b128 v[84:87], v14 offset:4096
    v_mfma_f32_32x32x16_bf16 v[144:159], v[116:119], v[88:91], v[144:159]
    buffer_load_dwordx4 v4, s[8:11], s56 offen offset:2048  lds
    ds_read_b64_tr_b16 v[96:97], v8 offset:8192
    ds_read_b64_tr_b16 v[98:99], v8 offset:9216
    v_mfma_f32_32x32x16_bf16 v[208:223], v[116:119], v[92:95], v[208:223]
    buffer_load_dwordx4 v5, s[8:11], s56 offen offset:3072  lds
    s_add_u32 s56, s56, 131072
    ds_read_b64_tr_b16 v[100:101], v9 offset:8192
    ds_read_b64_tr_b16 v[102:103], v9 offset:9216
    v_mfma_f32_32x32x16_bf16 v[160:175], v[120:123], v[88:91], v[160:175]
    ds_read_b64_tr_b16 v[104:105], v10 offset:8192
    ds_read_b64_tr_b16 v[106:107], v10 offset:9216
    v_mfma_f32_32x32x16_bf16 v[224:239], v[120:123], v[92:95], v[224:239]
    ds_read_b64_tr_b16 v[108:109], v11 offset:8192
    ds_read_b64_tr_b16 v[110:111], v11 offset:9216
    v_mfma_f32_32x32x16_bf16 v[176:191], v[124:127], v[88:91], v[176:191]
    s_add_u32 m0, s64, 4096
    s_nop 0
    buffer_load_dwordx4 v2, s[8:11], s56 offen offset:0  lds
    buffer_load_dwordx4 v3, s[8:11], s56 offen offset:1024  lds
    buffer_load_dwordx4 v4, s[8:11], s56 offen offset:2048  lds
    buffer_load_dwordx4 v5, s[8:11], s56 offen offset:3072  lds
    s_add_u32 s56, s56, 131072
    s_cmp_eq_u32 s56, s57
    s_cselect_b32 s56, s58, s56
    v_mfma_f32_32x32x16_bf16 v[240:255], v[124:127], v[92:95], v[240:255]
    s_cmp_lg_u32 s5, 0
    s_cbranch_scc1 Lg1
    s_mov_b32 m0, s65
    s_nop 0
    buffer_load_dwordx4 v25, s[16:19], s62 offen offset:0 nt lds
    buffer_load_dwordx4 v26, s[16:19], s62 offen offset:1024 nt lds
    buffer_load_dwordx4 v27, s[16:19], s62 offen offset:2048 nt lds
    buffer_load_dwordx4 v28, s[16:19], s62 offen offset:3072 nt lds
    s_add_u32 s79, s62, 4096
    s_add_u32 m0, s65, 4096
    s_nop 0
    buffer_load_dwordx4 v25, s[16:19], s79 offen offset:0 nt lds
    buffer_load_dwordx4 v26, s[16:19], s79 offen offset:1024 nt lds
    buffer_load_dwordx4 v27, s[16:19], s79 offen offset:2048 nt lds
    buffer_load_dwordx4 v28, s[16:19], s79 offen offset:3072 nt lds
Lg1:
    s_waitcnt lgkmcnt(0)
    v_mfma_f32_32x32x16_bf16 v[128:143], v[96:99], v[80:83], v[128:143]
    s_add_u32 m0, s64, 8192
    s_nop 0
    buffer_load_dwordx4 v2, s[8:11], s56 offen offset:0  lds
    v_mfma_f32_32x32x16_bf16 v[192:207], v[96:99], v[84:87], v[192:207]
    buffer_load_dwordx4 v3, s[8:11], s56 offen offset:1024  lds
    s_waitcnt vmcnt(20)
    ds_read_b128 v[88:91], v15 offset:0
    ds_read_b128 v[92:95], v15 offset:4096
    v_mfma_f32_32x32x16_bf16 v[144:159], v[100:103], v[80:83], v[144:159]
    buffer_load_dwordx4 v4, s[8:11], s56 offen offset:2048  lds
    ds_read_b64_tr_b16 v[112:113], v8 offset:12288
    ds_read_b64_tr_b16 v[114:115], v8 offset:13312
    v_mfma_f32_32x32x16_bf16 v[208:223], v[100:103], v[84:87], v[208:223]
    buffer_load_dwordx4 v5, s[8:11], s56 offen offset:3072  lds
    s_add_u32 s56, s56, 131072
    ds_read_b64_tr_b16 v[116:117], v9 offset:12288
    ds_read_b64_tr_b16 v[118:119], v9 offset:13312
    v_mfma_f32_32x32x16_bf16 v[160:175], v[104:107], v[80:83], v[160:175]
    ds_read_b64_tr_b16 v[120:121], v10 offset:12288
    ds_read_b64_tr_b16 v[122:123], v10 offset:13312
    v_mfma_f32_32x32x16_bf16 v[224:239], v[104:107], v[84:87], v[224:239]
    ds_read_b64_tr_b16 v[124:125], v11 offset:12288
    ds_read_b64_tr_b16 v[126:127], v11 offset:13312
    v_mfma_f32_32x32x16_bf16 v[176:191], v[108:111], v[80:83], v[176:191]
    v_mfma_f32_32x32x16_bf16 v[240:255], v[108:111], v[84:87], v[240:255]
    s_waitcnt lgkmcnt(0)
    s_waitcnt vmcnt(20)
    s_barrier
    v_mfma_f32_32x32x16_bf16 v[128:143], v[112:115], v[88:91], v[128:143]
    s_add_u32 m0, s64, 12288
    s_nop 0
    buffer_load_dwordx4 v2, s[8:11], s56 offen offset:0  lds
    v_mfma_f32_32x32x16_bf16 v[192:207], v[112:115], v[92:95], v[192:207]
    buffer_load_dwordx4 v3, s[8:11], s56 offen offset:1024  lds
    s_waitcnt vmcnt(18)
    ds_read_b128 v[80:83], v12 offset:8192
    ds_read_b128 v[84:87], v12 offset:12288
    v_mfma_f32_32x32x16_bf16 v[144:159], v[116:119], v[88:91], v[144:159]
    buffer_load_dwordx4 v4, s[8:11], s56 offen offset:2048  lds
    ds_read_b64_tr_b16 v[96:97], v8 offset:16384
    ds_read_b64_tr_b16 v[98:99], v8 offset:17408
    v_mfma_f32_32x32x16_bf16 v[208:223], v[116:119], v[92:95], v[208:223]
    buffer_load_dwordx4 v5, s[8:11], s56 offen offset:3072  lds
    s_add_u32 s56, s56, 131072
    ds_read_b64_tr_b16 v[100:101], v9 offset:16384
    ds_read_b64_tr_b16 v[102:103], v9 offset:17408
    v_mfma_f32_32x32x16_bf16 v[160:175], v[120:123], v[88:91], v[160:175]
    ds_read_b64_tr_b16 v[104:105], v10 offset:16384
    ds_read_b64_tr_b16 v[106:107], v10 offset:17408
    s_add_u32 m0, s66, 16384
    s_nop 0
    buffer_load_dwordx4 v6, s[12:15], s59 offen offset:0  lds
    buffer_load_dwordx4 v7, s[12:15], s59 offen offset:1024  lds
    s_add_u32 s59, s59, 128
    s_cmp_eq_u32 s59, s60
    s_cselect_b32 s59, s61, s59
    s_add_u32 m0, s66, 24576
    s_nop 0
    buffer_load_dwordx4 v6, s[12:15], s59 offen offset:0  lds
    buffer_load_dwordx4 v7, s[12:15], s59 offen offset:1024  lds
    s_add_u32 s59, s59, 128
    s_cmp_eq_u32 s59, s60
    s_cselect_b32 s59, s61, s59
    s_add_u32 m0, s66, 0
    s_nop 0
    buffer_load_dwordx4 v6, s[12:15], s59 offen offset:0  lds
    buffer_load_dwordx4 v7, s[12:15], s59 offen offset:1024  lds
    s_add_u32 s59, s59, 128
    s_cmp_eq_u32 s59, s60
    s_cselect_b32 s59, s61, s59
    v_mfma_f32_32x32x16_bf16 v[224:239], v[120:123], v[92:95], v[224:239]
    ds_read_b64_tr_b16 v[108:109], v11 offset:16384
    ds_read_b64_tr_b16 v[110:111], v11 offset:17408
    v_mfma_f32_32x32x16_bf16 v[176:191], v[124:127], v[88:91], v[176:191]
    v_mfma_f32_32x32x16_bf16 v[240:255], v[124:127], v[92:95], v[240:255]
    s_cmp_lg_u32 s5, 1
    s_cbranch_scc1 Lg2
    s_mov_b32 m0, s65
    s_nop 0
    buffer_load_dwordx4 v25, s[16:19], s62 offen offset:0 nt lds
    buffer_load_dwordx4 v26, s[16:19], s62 offen offset:1024 nt lds
    buffer_load_dwordx4 v27, s[16:19], s62 offen offset:2048 nt lds
    buffer_load_dwordx4 v28, s[16:19], s62 offen offset:3072 nt lds
    s_add_u32 s79, s62, 4096
    s_add_u32 m0, s65, 4096
    s_nop 0
    buffer_load_dwordx4 v25, s[16:19], s79 offen offset:0 nt lds
    buffer_load_dwordx4 v26, s[16:19], s79 offen offset:1024 nt lds
    buffer_load_dwordx4 v27, s[16:19], s79 offen offset:2048 nt lds
    buffer_load_dwordx4 v28, s[16:19], s79 offen offset:3072 nt lds
Lg2:
    s_waitcnt lgkmcnt(0)
    v_mfma_f32_32x32x16_bf16 v[128:143], v[96:99], v[80:83], v[128:143]
    s_add_u32 m0, s64, 16384
    s_nop 0
    buffer_load_dwordx4 v2, s[8:11], s56 offen offset:0  lds
    v_mfma_f32_32x32x16_bf16 v[192:207], v[96:99], v[84:87], v[192:207]
    buffer_load_dwordx4 v3, s[8:11], s56 offen offset:1024  lds
    s_waitcnt vmcnt(24)
    ds_read_b128 v[88:91], v13 offset:8192
    ds_read_b128 v[92:95], v13 offset:12288
    v_mfma_f32_32x32x16_bf16 v[144:159], v[100:103], v[80:83], v[144:159]
    buffer_load_dwordx4 v4, s[8:11], s56 offen offset:2048  lds
    ds_read_b64_tr_b16 v[112:113], v8 offset:20480
    ds_read_b64_tr_b16 v[114:115], v8 offset:21504
    v_mfma_f32_32x32x16_bf16 v[208:223], v[100:103], v[84:87], v[208:223]
    buffer_load_dwordx4 v5, s[8:11], s56 offen offset:3072  lds
    s_add_u32 s56, s56, 131072
    ds_read_b64_tr_b16 v[116:117], v9 offset:20480
    ds_read_b64_tr_b16 v[118:119], v9 offset:21504
    v_mfma_f32_32x32x16_bf16 v[160:175], v[104:107], v[80:83], v[160:175]
    ds_read_b64_tr_b16 v[120:121], v10 offset:20480
    ds_read_b64_tr_b16 v[122:123], v10 offset:21504
    v_mfma_f32_32x32x16_bf16 v[224:239], v[104:107], v[84:87], v[224:239]
    ds_read_b64_tr_b16 v[124:125], v11 offset:20480
    ds_read_b64_tr_b16 v[126:127], v11 offset:21504
    v_mfma_f32_32x32x16_bf16 v[176:191], v[108:111], v[80:83], v[176:191]
    v_mfma_f32_32x32x16_bf16 v[240:255], v[108:111], v[84:87], v[240:255]
    s_waitcnt lgkmcnt(0)
    v_mfma_f32_32x32x16_bf16 v[128:143], v[112:115], v[88:91], v[128:143]
    s_add_u32 m0, s64, 20480
    s_nop 0
    buffer_load_dwordx4 v2, s[8:11], s56 offen offset:0  lds
    v_mfma_f32_32x32x16_bf16 v[192:207], v[112:115], v[92:95], v[192:207]
    buffer_load_dwordx4 v3, s[8:11], s56 offen offset:1024  lds
    s_waitcnt vmcnt(24)
    ds_read_b128 v[80:83], v14 offset:8192
    ds_read_b128 v[84:87], v14 offset:12288
    v_mfma_f32_32x32x16_bf16 v[144:159], v[116:119], v[88:91], v[144:159]
    buffer_load_dwordx4 v4, s[8:11], s56 offen offset:2048  lds
    ds_read_b64_tr_b16 v[96:97], v8 offset:0
    ds_read_b64_tr_b16 v[98:99], v8 offset:1024
    v_mfma_f32_32x32x16_bf16 v[208:223], v[116:119], v[92:95], v[208:223]
    buffer_load_dwordx4 v5, s[8:11], s56 offen offset:3072  lds
    s_add_u32 s56, s56, 131072
    s_cmp_eq_u32 s56, s57
    s_cselect_b32 s56, s58, s56
    ds_read_b64_tr_b16 v[100:101], v9 offset:0
    ds_read_b64_tr_b16 v[102:103], v9 offset:1024
    v_mfma_f32_32x32x16_bf16 v[160:175], v[120:123], v[88:91], v[160:175]
    ds_read_b64_tr_b16 v[104:105], v10 offset:0
    ds_read_b64_tr_b16 v[106:107], v10 offset:1024
    v_mfma_f32_32x32x16_bf16 v[224:239], v[120:123], v[92:95], v[224:239]
    ds_read_b64_tr_b16 v[108:109], v11 offset:0
    ds_read_b64_tr_b16 v[110:111], v11 offset:1024
    v_mfma_f32_32x32x16_bf16 v[176:191], v[124:127], v[88:91], v[176:191]
    v_mfma_f32_32x32x16_bf16 v[240:255], v[124:127], v[92:95], v[240:255]
    s_cmp_lg_u32 s5, 2
    s_cbranch_scc1 Lg3
    s_mov_b32 m0, s65
    s_nop 0
    buffer_load_dwordx4 v25, s[16:19], s62 offen offset:0 nt lds
    buffer_load_dwordx4 v26, s[16:19], s62 offen offset:1024 nt lds
    buffer_load_dwordx4 v27, s[16:19], s62 offen offset:2048 nt lds
    buffer_load_dwordx4 v28, s[16:19], s62 offen offset:3072 nt lds
    s_add_u32 s79, s62, 4096
    s_add_u32 m0, s65, 4096
    s_nop 0
    buffer_load_dwordx4 v25, s[16:19], s79 offen offset:0 nt lds
    buffer_load_dwordx4 v26, s[16:19], s79 offen offset:1024 nt lds
    buffer_load_dwordx4 v27, s[16:19], s79 offen offset:2048 nt lds
    buffer_load_dwordx4 v28, s[16:19], s79 offen offset:3072 nt lds
Lg3:
    s_waitcnt lgkmcnt(0)
    v_mfma_f32_32x32x16_bf16 v[128:143], v[96:99], v[80:83], v[128:143]
    s_add_u32 m0, s64, 0
    s_nop 0
    buffer_load_dwordx4 v2, s[8:11], s56 offen offset:0  lds
    v_mfma_f32_32x32x16_bf16 v[192:207], v[96:99], v[84:87], v[192:207]
    buffer_load_dwordx4 v3, s[8:11], s56 offen offset:1024  lds
    s_waitcnt vmcnt(24)
    ds_read_b128 v[88:91], v15 offset:8192
    ds_read_b128 v[92:95], v15 offset:12288
    v_mfma_f32_32x32x16_bf16 v[144:159], v[100:103], v[80:83], v[144:159]
    buffer_load_dwordx4 v4, s[8:11], s56 offen offset:2048  lds
    ds_read_b64_tr_b16 v[112:113], v8 offset:4096
    ds_read_b64_tr_b16 v[114:115], v8 offset:5120
    v_mfma_f32_32x32x16_bf16 v[208:223], v[100:103], v[84:87], v[208:223]
    buffer_load_dwordx4 v5, s[8:11], s56 offen offset:3072  lds
    s_add_u32 s56, s56, 131072
    ds_read_b64_tr_b16 v[116:117], v9 offset:4096
    ds_read_b64_tr_b16 v[118:119], v9 offset:5120
    v_mfma_f32_32x32x16_bf16 v[160:175], v[104:107], v[80:83], v[160:175]
    ds_read_b64_tr_b16 v[120:121], v10 offset:4096
    ds_read_b64_tr_b16 v[122:123], v10 offset:5120
    v_mfma_f32_32x32x16_bf16 v[224:239], v[104:107], v[84:87], v[224:239]
    ds_read_b64_tr_b16 v[124:125], v11 offset:4096
    ds_read_b64_tr_b16 v[126:127], v11 offset:5120
    v_mfma_f32_32x32x16_bf16 v[176:191], v[108:111], v[80:83], v[176:191]
    v_mfma_f32_32x32x16_bf16 v[240:255], v[108:111], v[84:87], v[240:255]
    s_waitcnt lgkmcnt(0)
    s_waitcnt vmcnt(16)
    s_barrier
    v_mfma_f32_32x32x16_bf16 v[128:143], v[112:115], v[88:91], v[128:143]
    s_add_u32 m0, s64, 4096
    s_nop 0
    buffer_load_dwordx4 v2, s[8:11], s56 offen offset:0  lds
    v_mfma_f32_32x32x16_bf16 v[192:207], v[112:115], v[92:95], v[192:207]
    buffer_load_dwordx4 v3, s[8:11], s56 offen offset:1024  lds
    ds_read_b128 v[80:83], v12 offset:16384
    ds_read_b128 v[84:87], v12 offset:20480
    v_mfma_f32_32x32x16_bf16 v[144:159], v[116:119], v[88:91], v[144:159]
    buffer_load_dwordx4 v4, s[8:11], s56 offen offset:2048  lds
    ds_read_b64_tr_b16 v[96:97], v8 offset:8192
    ds_read_b64_tr_b16 v[98:99], v8 offset:9216
    v_mfma_f32_32x32x16_bf16 v[208:223], v[116:119], v[92:95], v[208:223]
    buffer_load_dwordx4 v5, s[8:11], s56 offen offset:3072  lds
    s_add_u32 s56, s56, 131072
    ds_read_b64_tr_b16 v[100:101], v9 offset:8192
    ds_read_b64_tr_b16 v[102:103], v9 offset:9216
    v_mfma_f32_32x32x16_bf16 v[160:175], v[120:123], v[88:91], v[160:175]
    ds_read_b64_tr_b16 v[104:105], v10 offset:8192
    ds_read_b64_tr_b16 v[106:107], v10 offset:9216
    s_add_u32 m0, s66, 8192
    s_nop 0
    buffer_load_dwordx4 v6, s[12:15], s59 offen offset:0  lds
    buffer_load_dwordx4 v7, s[12:15], s59 offen offset:1024  lds
    s_add_u32 s59, s59, 128
    s_cmp_eq_u32 s59, s60
    s_cselect_b32 s59, s61, s59
    v_mfma_f32_32x32x16_bf16 v[224:239], v[120:123], v[92:95], v[224:239]
    ds_read_b64_tr_b16 v[108:109], v11 offset:8192
    ds_read_b64_tr_b16 v[110:111], v11 offset:9216
    v_mfma_f32_32x32x16_bf16 v[176:191], v[124:127], v[88:91], v[176:191]
    s_cmp_lg_u32 s5, 0
    s_cbranch_scc1 Lg4
    ds_read_b128 a[0:3], v30
    v_xor_b32 v17, 32, v30
    ds_read_b128 a[4:7], v17
    v_xor_b32 v18, 64, v30
    ds_read_b128 a[8:11], v18
    v_xor_b32 v19, 96, v30
    ds_read_b128 a[12:15], v19
Lg4:
    v_mfma_f32_32x32x16_bf16 v[240:255], v[124:127], v[92:95], v[240:255]
    s_cmp_lg_u32 s5, 3
    s_cbranch_scc1 Lg5
    s_mov_b32 m0, s65
    s_nop 0
    buffer_load_dwordx4 v25, s[16:19], s62 offen offset:0 nt lds
    buffer_load_dwordx4 v26, s[16:19], s62 offen offset:1024 nt lds
    buffer_load_dwordx4 v27, s[16:19], s62 offen offset:2048 nt lds
    buffer_load_dwordx4 v28, s[16:19], s62 offen offset:3072 nt lds
    s_add_u32 s79, s62, 4096
    s_add_u32 m0, s65, 4096
    s_nop 0
    buffer_load_dwordx4 v25, s[16:19], s79 offen offset:0 nt lds
    buffer_load_dwordx4 v26, s[16:19], s79 offen offset:1024 nt lds
    buffer_load_dwordx4 v27, s[16:19], s79 offen offset:2048 nt lds
    buffer_load_dwordx4 v28, s[16:19], s79 offen offset:3072 nt lds
Lg5:
    s_waitcnt lgkmcnt(0)
    v_mfma_f32_32x32x16_bf16 v[128:143], v[96:99], v[80:83], v[128:143]
    s_add_u32 m0, s64, 8192
    s_nop 0
    buffer_load_dwordx4 v2, s[8:11], s56 offen offset:0  lds
    v_mfma_f32_32x32x16_bf16 v[192:207], v[96:99], v[84:87], v[192:207]
    buffer_load_dwordx4 v3, s[8:11], s56 offen offset:1024  lds
    ds_read_b128 v[88:91], v13 offset:16384
    ds_read_b128 v[92:95], v13 offset:20480
    v_mfma_f32_32x32x16_bf16 v[144:159], v[100:103], v[80:83], v[144:159]
    buffer_load_dwordx4 v4, s[8:11], s56 offen offset:2048  lds
    ds_read_b64_tr_b16 v[112:113], v8 offset:12288
    ds_read_b64_tr_b16 v[114:115], v8 offset:13312
    v_mfma_f32_32x32x16_bf16 v[208:223], v[100:103], v[84:87], v[208:223]
    buffer_load_dwordx4 v5, s[8:11], s56 offen offset:3072  lds
    s_add_u32 s56, s56, 131072
    ds_read_b64_tr_b16 v[116:117], v9 offset:12288
    ds_read_b64_tr_b16 v[118:119], v9 offset:13312
    v_mfma_f32_32x32x16_bf16 v[160:175], v[104:107], v[80:83], v[160:175]
    ds_read_b64_tr_b16 v[120:121], v10 offset:12288
    ds_read_b64_tr_b16 v[122:123], v10 offset:13312
    v_mfma_f32_32x32x16_bf16 v[224:239], v[104:107], v[84:87], v[224:239]
    ds_read_b64_tr_b16 v[124:125], v11 offset:12288
    ds_read_b64_tr_b16 v[126:127], v11 offset:13312
    v_mfma_f32_32x32x16_bf16 v[176:191], v[108:111], v[80:83], v[176:191]
    s_cmp_lg_u32 s5, 0
    s_cbranch_scc1 Lg6
    v_xor_b32 v20, 128, v30
    ds_read_b128 a[16:19], v20
    v_xor_b32 v21, 160, v30
    ds_read_b128 a[20:23], v21
    v_xor_b32 v22, 192, v30
    ds_read_b128 a[24:27], v22
    v_xor_b32 v23, 224, v30
    ds_read_b128 a[28:31], v23
Lg6:
    v_mfma_f32_32x32x16_bf16 v[240:255], v[108:111], v[84:87], v[240:255]
    s_waitcnt lgkmcnt(0)
    v_mfma_f32_32x32x16_bf16 v[128:143], v[112:115], v[88:91], v[128:143]
    s_add_u32 m0, s64, 12288
    s_nop 0
    buffer_load_dwordx4 v2, s[8:11], s56 offen offset:0  lds
    v_mfma_f32_32x32x16_bf16 v[192:207], v[112:115], v[92:95], v[192:207]
    buffer_load_dwordx4 v3, s[8:11], s56 offen offset:1024  lds
    s_waitcnt vmcnt(20)
    ds_read_b128 v[80:83], v14 offset:16384
    ds_read_b128 v[84:87], v14 offset:20480
    v_mfma_f32_32x32x16_bf16 v[144:159], v[116:119], v[88:91], v[144:159]
    buffer_load_dwordx4 v4, s[8:11], s56 offen offset:2048  lds
    ds_read_b64_tr_b16 v[96:97], v8 offset:16384
    ds_read_b64_tr_b16 v[98:99], v8 offset:17408
    v_mfma_f32_32x32x16_bf16 v[208:223], v[116:119], v[92:95], v[208:223]
    buffer_load_dwordx4 v5, s[8:11], s56 offen offset:3072  lds
    s_add_u32 s56, s56, 131072
    s_cmp_eq_u32 s56, s57
    s_cselect_b32 s56, s58, s56
    ds_read_b64_tr_b16 v[100:101], v9 offset:16384
    ds_read_b64_tr_b16 v[102:103], v9 offset:17408
    v_mfma_f32_32x32x16_bf16 v[160:175], v[120:123], v[88:91], v[160:175]
    ds_read_b64_tr_b16 v[104:105], v10 offset:16384
    ds_read_b64_tr_b16 v[106:107], v10 offset:17408
    v_mfma_f32_32x32x16_bf16 v[224:239], v[120:123], v[92:95], v[224:239]
    ds_read_b64_tr_b16 v[108:109], v11 offset:16384
    ds_read_b64_tr_b16 v[110:111], v11 offset:17408
    v_mfma_f32_32x32x16_bf16 v[176:191], v[124:127], v[88:91], v[176:191]
    s_cmp_lg_u32 s5, 1
    s_cbranch_scc1 Lg7
    ds_read_b128 a[0:3], v30
    v_xor_b32 v17, 32, v30
    ds_read_b128 a[4:7], v17
    v_xor_b32 v18, 64, v30
    ds_read_b128 a[8:11], v18
    v_xor_b32 v19, 96, v30
    ds_read_b128 a[12:15], v19
Lg7:
    v_mfma_f32_32x32x16_bf16 v[240:255], v[124:127], v[92:95], v[240:255]
    s_cmp_lg_u32 s5, 0
    s_cbranch_scc1 Lg8
    s_mov_b32 m0, s65
    s_nop 0
    buffer_load_dwordx4 v25, s[16:19], s63 offen offset:0 nt lds
    buffer_load_dwordx4 v26, s[16:19], s63 offen offset:1024 nt lds
    buffer_load_dwordx4 v27, s[16:19], s63 offen offset:2048 nt lds
    buffer_load_dwordx4 v28, s[16:19], s63 offen offset:3072 nt lds
    s_add_u32 s79, s63, 4096
    s_add_u32 m0, s65, 4096
    s_nop 0
    buffer_load_dwordx4 v25, s[16:19], s79 offen offset:0 nt lds
    buffer_load_dwordx4 v26, s[16:19], s79 offen offset:1024 nt lds
    buffer_load_dwordx4 v27, s[16:19], s79 offen offset:2048 nt lds
    buffer_load_dwordx4 v28, s[16:19], s79 offen offset:3072 nt lds
Lg8:
    s_waitcnt lgkmcnt(0)
    v_mfma_f32_32x32x16_bf16 v[128:143], v[96:99], v[80:83], v[128:143]
    s_add_u32 m0, s64, 16384
    s_nop 0
    buffer_load_dwordx4 v2, s[8:11], s56 offen offset:0  lds
    v_mfma_f32_32x32x16_bf16 v[192:207], v[96:99], v[84:87], v[192:207]
    buffer_load_dwordx4 v3, s[8:11], s56 offen offset:1024  lds
    s_waitcnt vmcnt(20)
    ds_read_b128 v[88:91], v15 offset:16384
    ds_read_b128 v[92:95], v15 offset:20480
    v_mfma_f32_32x32x16_bf16 v[144:159], v[100:103], v[80:83], v[144:159]
    buffer_load_dwordx4 v4, s[8:11], s56 offen offset:2048  lds
    ds_read_b64_tr_b16 v[112:113], v8 offset:20480
    ds_read_b64_tr_b16 v[114:115], v8 offset:21504
    v_mfma_f32_32x32x16_bf16 v[208:223], v[100:103], v[84:87], v[208:223]
    buffer_load_dwordx4 v5, s[8:11], s56 offen offset:3072  lds
    s_add_u32 s56, s56, 131072
    ds_read_b64_tr_b16 v[116:117], v9 offset:20480
    ds_read_b64_tr_b16 v[118:119], v9 offset:21504
    v_mfma_f32_32x32x16_bf16 v[160:175], v[104:107], v[80:83], v[160:175]
    ds_read_b64_tr_b16 v[120:121], v10 offset:20480
    ds_read_b64_tr_b16 v[122:123], v10 offset:21504
    v_mfma_f32_32x32x16_bf16 v[224:239], v[104:107], v[84:87], v[224:239]
    ds_read_b64_tr_b16 v[124:125], v11 offset:20480
    ds_read_b64_tr_b16 v[126:127], v11 offset:21504
    v_mfma_f32_32x32x16_bf16 v[176:191], v[108:111], v[80:83], v[176:191]
    s_cmp_lg_u32 s5, 1
    s_cbranch_scc1 Lg9
    v_xor_b32 v20, 128, v30
    ds_read_b128 a[16:19], v20
    v_xor_b32 v21, 160, v30
    ds_read_b128 a[20:23], v21
    v_xor_b32 v22, 192, v30
    ds_read_b128 a[24:27], v22
    v_xor_b32 v23, 224, v30
    ds_read_b128 a[28:31], v23
Lg9:
    v_mfma_f32_32x32x16_bf16 v[240:255], v[108:111], v[84:87], v[240:255]
    s_waitcnt lgkmcnt(0)
    s_barrier
    v_mfma_f32_32x32x16_bf16 v[128:143], v[112:115], v[88:91], v[128:143]
    s_add_u32 m0, s64, 20480
    s_nop 0
    buffer_load_dwordx4 v2, s[8:11], s56 offen offset:0  lds
    v_mfma_f32_32x32x16_bf16 v[192:207], v[112:115], v[92:95], v[192:207]
    buffer_load_dwordx4 v3, s[8:11], s56 offen offset:1024  lds
    s_waitcnt vmcnt(20)
    ds_read_b128 v[80:83], v12 offset:24576
    ds_read_b128 v[84:87], v12 offset:28672
    v_mfma_f32_32x32x16_bf16 v[144:159], v[116:119], v[88:91], v[144:159]
    buffer_load_dwordx4 v4, s[8:11], s56 offen offset:2048  lds
    ds_read_b64_tr_b16 v[96:97], v8 offset:0
    ds_read_b64_tr_b16 v[98:99], v8 offset:1024
    v_mfma_f32_32x32x16_bf16 v[208:223], v[116:119], v[92:95], v[208:223]
    buffer_load_dwordx4 v5, s[8:11], s56 offen offset:3072  lds
    s_add_u32 s56, s56, 131072
    ds_read_b64_tr_b16 v[100:101], v9 offset:0
    ds_read_b64_tr_b16 v[102:103], v9 offset:1024
    v_mfma_f32_32x32x16_bf16 v[160:175], v[120:123], v[88:91], v[160:175]
    ds_read_b64_tr_b16 v[104:105], v10 offset:0
    ds_read_b64_tr_b16 v[106:107], v10 offset:1024
    s_add_u32 m0, s66, 16384
    s_nop 0
    buffer_load_dwordx4 v6, s[12:15], s59 offen offset:0  lds
    buffer_load_dwordx4 v7, s[12:15], s59 offen offset:1024  lds
    s_add_u32 s59, s59, 128
    s_cmp_eq_u32 s59, s60
    s_cselect_b32 s59, s61, s59
    v_mfma_f32_32x32x16_bf16 v[224:239], v[120:123], v[92:95], v[224:239]
    ds_read_b64_tr_b16 v[108:109], v11 offset:0
    ds_read_b64_tr_b16 v[110:111], v11 offset:1024
    v_mfma_f32_32x32x16_bf16 v[176:191], v[124:127], v[88:91], v[176:191]
    s_cmp_lg_u32 s5, 2
    s_cbranch_scc1 Lg10
    ds_read_b128 a[0:3], v30
    v_xor_b32 v17, 32, v30
    ds_read_b128 a[4:7], v17
    v_xor_b32 v18, 64, v30
    ds_read_b128 a[8:11], v18
    v_xor_b32 v19, 96, v30
    ds_read_b128 a[12:15], v19
Lg10:
    v_mfma_f32_32x32x16_bf16 v[240:255], v[124:127], v[92:95], v[240:255]
    s_cmp_lg_u32 s5, 1
    s_cbranch_scc1 Lg11
    s_mov_b32 m0, s65
    s_nop 0
    buffer_load_dwordx4 v25, s[16:19], s63 offen offset:0 nt lds
    buffer_load_dwordx4 v26, s[16:19], s63 offen offset:1024 nt lds
    buffer_load_dwordx4 v27, s[16:19], s63 offen offset:2048 nt lds
    buffer_load_dwordx4 v28, s[16:19], s63 offen offset:3072 nt lds
    s_add_u32 s79, s63, 4096
    s_add_u32 m0, s65, 4096
    s_nop 0
    buffer_load_dwordx4 v25, s[16:19], s79 offen offset:0 nt lds
    buffer_load_dwordx4 v26, s[16:19], s79 offen offset:1024 nt lds
    buffer_load_dwordx4 v27, s[16:19], s79 offen offset:2048 nt lds
    buffer_load_dwordx4 v28, s[16:19], s79 offen offset:3072 nt lds
Lg11:
    s_waitcnt lgkmcnt(0)
    v_mfma_f32_32x32x16_bf16 v[128:143], v[96:99], v[80:83], v[128:143]
    s_add_u32 m0, s64, 0
    s_nop 0
    buffer_load_dwordx4 v2, s[8:11], s56 offen offset:0  lds
    v_mfma_f32_32x32x16_bf16 v[192:207], v[96:99], v[84:87], v[192:207]
    buffer_load_dwordx4 v3, s[8:11], s56 offen offset:1024  lds
    s_waitcnt vmcnt(22)
    ds_read_b128 v[88:91], v13 offset:24576
    ds_read_b128 v[92:95], v13 offset:28672
    v_mfma_f32_32x32x16_bf16 v[144:159], v[100:103], v[80:83], v[144:159]
    buffer_load_dwordx4 v4, s[8:11], s56 offen offset:2048  lds
    ds_read_b64_tr_b16 v[112:113], v8 offset:4096
    ds_read_b64_tr_b16 v[114:115], v8 offset:5120
    v_mfma_f32_32x32x16_bf16 v[208:223], v[100:103], v[84:87], v[208:223]
    buffer_load_dwordx4 v5, s[8:11], s56 offen offset:3072  lds
    s_add_u32 s56, s56, 131072
    ds_read_b64_tr_b16 v[116:117], v9 offset:4096
    ds_read_b64_tr_b16 v[118:119], v9 offset:5120
    v_mfma_f32_32x32x16_bf16 v[160:175], v[104:107], v[80:83], v[160:175]
    ds_read_b64_tr_b16 v[120:121], v10 offset:4096
    ds_read_b64_tr_b16 v[122:123], v10 offset:5120
    v_mfma_f32_32x32x16_bf16 v[224:239], v[104:107], v[84:87], v[224:239]
    ds_read_b64_tr_b16 v[124:125], v11 offset:4096
    ds_read_b64_tr_b16 v[126:127], v11 offset:5120
    v_mfma_f32_32x32x16_bf16 v[176:191], v[108:111], v[80:83], v[176:191]
    s_cmp_lg_u32 s5, 2
    s_cbranch_scc1 Lg12
    v_xor_b32 v20, 128, v30
    ds_read_b128 a[16:19], v20
    v_xor_b32 v21, 160, v30
    ds_read_b128 a[20:23], v21
    v_xor_b32 v22, 192, v30
    ds_read_b128 a[24:27], v22
    v_xor_b32 v23, 224, v30
    ds_read_b128 a[28:31], v23
Lg12:
    v_mfma_f32_32x32x16_bf16 v[240:255], v[108:111], v[84:87], v[240:255]
    s_waitcnt lgkmcnt(0)
    v_mfma_f32_32x32x16_bf16 v[128:143], v[112:115], v[88:91], v[128:143]
    s_add_u32 m0, s64, 4096
    s_nop 0
    buffer_load_dwordx4 v2, s[8:11], s56 offen offset:0  lds
    v_mfma_f32_32x32x16_bf16 v[192:207], v[112:115], v[92:95], v[192:207]
    buffer_load_dwordx4 v3, s[8:11], s56 offen offset:1024  lds
    s_waitcnt vmcnt(20)
    ds_read_b128 v[80:83], v14 offset:24576
    ds_read_b128 v[84:87], v14 offset:28672
    v_mfma_f32_32x32x16_bf16 v[144:159], v[116:119], v[88:91], v[144:159]
    buffer_load_dwordx4 v4, s[8:11], s56 offen offset:2048  lds
    ds_read_b64_tr_b16 v[96:97], v8 offset:8192
    ds_read_b64_tr_b16 v[98:99], v8 offset:9216
    v_mfma_f32_32x32x16_bf16 v[208:223], v[116:119], v[92:95], v[208:223]
    buffer_load_dwordx4 v5, s[8:11], s56 offen offset:3072  lds
    s_add_u32 s56, s56, 131072
    s_cmp_eq_u32 s56, s57
    s_cselect_b32 s56, s58, s56
    ds_read_b64_tr_b16 v[100:101], v9 offset:8192
    ds_read_b64_tr_b16 v[102:103], v9 offset:9216
    v_mfma_f32_32x32x16_bf16 v[160:175], v[120:123], v[88:91], v[160:175]
    ds_read_b64_tr_b16 v[104:105], v10 offset:8192
    ds_read_b64_tr_b16 v[106:107], v10 offset:9216
    v_mfma_f32_32x32x16_bf16 v[224:239], v[120:123], v[92:95], v[224:239]
    ds_read_b64_tr_b16 v[108:109], v11 offset:8192
    ds_read_b64_tr_b16 v[110:111], v11 offset:9216
    v_mfma_f32_32x32x16_bf16 v[176:191], v[124:127], v[88:91], v[176:191]
    s_cmp_lg_u32 s5, 3
    s_cbranch_scc1 Lg13
    ds_read_b128 a[0:3], v30
    v_xor_b32 v17, 32, v30
    ds_read_b128 a[4:7], v17
    v_xor_b32 v18, 64, v30
    ds_read_b128 a[8:11], v18
    v_xor_b32 v19, 96, v30
    ds_read_b128 a[12:15], v19
Lg13:
    v_mfma_f32_32x32x16_bf16 v[240:255], v[124:127], v[92:95], v[240:255]
    s_cmp_lg_u32 s5, 2
    s_cbranch_scc1 Lg14
    s_mov_b32 m0, s65
    s_nop 0
    buffer_load_dwordx4 v25, s[16:19], s63 offen offset:0 nt lds
    buffer_load_dwordx4 v26, s[16:19], s63 offen offset:1024 nt lds
    buffer_load_dwordx4 v27, s[16:19], s63 offen offset:2048 nt lds
    buffer_load_dwordx4 v28, s[16:19], s63 offen offset:3072 nt lds
    s_add_u32 s79, s63, 4096
    s_add_u32 m0, s65, 4096
    s_nop 0
    buffer_load_dwordx4 v25, s[16:19], s79 offen offset:0 nt lds
    buffer_load_dwordx4 v26, s[16:19], s79 offen offset:1024 nt lds
    buffer_load_dwordx4 v27, s[16:19], s79 offen offset:2048 nt lds
    buffer_load_dwordx4 v28, s[16:19], s79 offen offset:3072 nt lds
Lg14:
    s_waitcnt lgkmcnt(0)
    v_mfma_f32_32x32x16_bf16 v[128:143], v[96:99], v[80:83], v[128:143]
    s_add_u32 m0, s64, 8192
    s_nop 0
    buffer_load_dwordx4 v2, s[8:11], s56 offen offset:0  lds
    v_mfma_f32_32x32x16_bf16 v[192:207], v[96:99], v[84:87], v[192:207]
    buffer_load_dwordx4 v3, s[8:11], s56 offen offset:1024  lds
    s_waitcnt vmcnt(20)
    ds_read_b128 v[88:91], v15 offset:24576
    ds_read_b128 v[92:95], v15 offset:28672
    v_mfma_f32_32x32x16_bf16 v[144:159], v[100:103], v[80:83], v[144:159]
    buffer_load_dwordx4 v4, s[8:11], s56 offen offset:2048  lds
    ds_read_b64_tr_b16 v[112:113], v8 offset:12288
    ds_read_b64_tr_b16 v[114:115], v8 offset:13312
    v_mfma_f32_32x32x16_bf16 v[208:223], v[100:103], v[84:87], v[208:223]
    buffer_load_dwordx4 v5, s[8:11], s56 offen offset:3072  lds
    s_add_u32 s56, s56, 131072
    ds_read_b64_tr_b16 v[116:117], v9 offset:12288
    ds_read_b64_tr_b16 v[118:119], v9 offset:13312
    v_mfma_f32_32x32x16_bf16 v[160:175], v[104:107], v[80:83], v[160:175]
    ds_read_b64_tr_b16 v[120:121], v10 offset:12288
    ds_read_b64_tr_b16 v[122:123], v10 offset:13312
    v_mfma_f32_32x32x16_bf16 v[224:239], v[104:107], v[84:87], v[224:239]
    ds_read_b64_tr_b16 v[124:125], v11 offset:12288
    ds_read_b64_tr_b16 v[126:127], v11 offset:13312
    v_mfma_f32_32x32x16_bf16 v[176:191], v[108:111], v[80:83], v[176:191]
    s_cmp_lg_u32 s5, 3
    s_cbranch_scc1 Lg15
    v_xor_b32 v20, 128, v30
    ds_read_b128 a[16:19], v20
    v_xor_b32 v21, 160, v30
    ds_read_b128 a[20:23], v21
    v_xor_b32 v22, 192, v30
    ds_read_b128 a[24:27], v22
    v_xor_b32 v23, 224, v30
    ds_read_b128 a[28:31], v23
Lg15:
    v_mfma_f32_32x32x16_bf16 v[240:255], v[108:111], v[84:87], v[240:255]
    s_waitcnt lgkmcnt(0)
    s_barrier
    v_mfma_f32_32x32x16_bf16 v[128:143], v[112:115], v[88:91], v[128:143]
    s_add_u32 m0, s64, 12288
    s_nop 0
    buffer_load_dwordx4 v2, s[8:11], s56 offen offset:0  lds
    v_mfma_f32_32x32x16_bf16 v[192:207], v[112:115], v[92:95], v[192:207]
    buffer_load_dwordx4 v3, s[8:11], s56 offen offset:1024  lds
    s_waitcnt vmcnt(20)
    ds_read_b128 v[80:83], v12 offset:0
    ds_read_b128 v[84:87], v12 offset:4096
    v_mfma_f32_32x32x16_bf16 v[144:159], v[116:119], v[88:91], v[144:159]
    buffer_load_dwordx4 v4, s[8:11], s56 offen offset:2048  lds
    ds_read_b64_tr_b16 v[96:97], v8 offset:16384
    ds_read_b64_tr_b16 v[98:99], v8 offset:17408
    v_mfma_f32_32x32x16_bf16 v[208:223], v[116:119], v[92:95], v[208:223]
    buffer_load_dwordx4 v5, s[8:11], s56 offen offset:3072  lds
    s_add_u32 s56, s56, 131072
    ds_read_b64_tr_b16 v[100:101], v9 offset:16384
    ds_read_b64_tr_b16 v[102:103], v9 offset:17408
    v_mfma_f32_32x32x16_bf16 v[160:175], v[120:123], v[88:91], v[160:175]
    ds_read_b64_tr_b16 v[104:105], v10 offset:16384
    ds_read_b64_tr_b16 v[106:107], v10 offset:17408
    s_add_u32 m0, s66, 24576
    s_nop 0
    buffer_load_dwordx4 v6, s[12:15], s59 offen offset:0  lds
    buffer_load_dwordx4 v7, s[12:15], s59 offen offset:1024  lds
    s_add_u32 s59, s59, 128
    s_cmp_eq_u32 s59, s60
    s_cselect_b32 s59, s61, s59
    v_mfma_f32_32x32x16_bf16 v[224:239], v[120:123], v[92:95], v[224:239]
    ds_read_b64_tr_b16 v[108:109], v11 offset:16384
    ds_read_b64_tr_b16 v[110:111], v11 offset:17408
    v_mfma_f32_32x32x16_bf16 v[176:191], v[124:127], v[88:91], v[176:191]
    s_cmp_lg_u32 s5, 0
    s_cbranch_scc1 Lg16
    ds_read_b128 a[32:35], v30
    v_xor_b32 v17, 32, v30
    ds_read_b128 a[36:39], v17
    v_xor_b32 v18, 64, v30
    ds_read_b128 a[40:43], v18
    v_xor_b32 v19, 96, v30
    ds_read_b128 a[44:47], v19
Lg16:
    v_mfma_f32_32x32x16_bf16 v[240:255], v[124:127], v[92:95], v[240:255]
    s_cmp_lg_u32 s5, 3
    s_cbranch_scc1 Lg17
    s_mov_b32 m0, s65
    s_nop 0
    buffer_load_dwordx4 v25, s[16:19], s63 offen offset:0 nt lds
    buffer_load_dwordx4 v26, s[16:19], s63 offen offset:1024 nt lds
    buffer_load_dwordx4 v27, s[16:19], s63 offen offset:2048 nt lds
    buffer_load_dwordx4 v28, s[16:19], s63 offen offset:3072 nt lds
    s_add_u32 s79, s63, 4096
    s_add_u32 m0, s65, 4096
    s_nop 0
    buffer_load_dwordx4 v25, s[16:19], s79 offen offset:0 nt lds
    buffer_load_dwordx4 v26, s[16:19], s79 offen offset:1024 nt lds
    buffer_load_dwordx4 v27, s[16:19], s79 offen offset:2048 nt lds
    buffer_load_dwordx4 v28, s[16:19], s79 offen offset:3072 nt lds
Lg17:
    s_waitcnt lgkmcnt(0)
    v_mfma_f32_32x32x16_bf16 v[128:143], v[96:99], v[80:83], v[128:143]
    s_add_u32 m0, s64, 16384
    s_nop 0
    buffer_load_dwordx4 v2, s[8:11], s56 offen offset:0  lds
    v_mfma_f32_32x32x16_bf16 v[192:207], v[96:99], v[84:87], v[192:207]
    buffer_load_dwordx4 v3, s[8:11], s56 offen offset:1024  lds
    s_waitcnt vmcnt(22)
    ds_read_b128 v[88:91], v13 offset:0
    ds_read_b128 v[92:95], v13 offset:4096
    v_mfma_f32_32x32x16_bf16 v[144:159], v[100:103], v[80:83], v[144:159]
    buffer_load_dwordx4 v4, s[8:11], s56 offen offset:2048  lds
    ds_read_b64_tr_b16 v[112:113], v8 offset:20480
    ds_read_b64_tr_b16 v[114:115], v8 offset:21504
    v_mfma_f32_32x32x16_bf16 v[208:223], v[100:103], v[84:87], v[208:223]
    buffer_load_dwordx4 v5, s[8:11], s56 offen offset:3072  lds
    s_add_u32 s56, s56, 131072
    ds_read_b64_tr_b16 v[116:117], v9 offset:20480
    ds_read_b64_tr_b16 v[118:119], v9 offset:21504
    v_mfma_f32_32x32x16_bf16 v[160:175], v[104:107], v[80:83], v[160:175]
    ds_read_b64_tr_b16 v[120:121], v10 offset:20480
    ds_read_b64_tr_b16 v[122:123], v10 offset:21504
    v_mfma_f32_32x32x16_bf16 v[224:239], v[104:107], v[84:87], v[224:239]
    ds_read_b64_tr_b16 v[124:125], v11 offset:20480
    ds_read_b64_tr_b16 v[126:127], v11 offset:21504
    v_mfma_f32_32x32x16_bf16 v[176:191], v[108:111], v[80:83], v[176:191]
    s_cmp_lg_u32 s5, 0
    s_cbranch_scc1 Lg18
    v_xor_b32 v20, 128, v30
    ds_read_b128 a[48:51], v20
    v_xor_b32 v21, 160, v30
    ds_read_b128 a[52:55], v21
    v_xor_b32 v22, 192, v30
    ds_read_b128 a[56:59], v22
    v_xor_b32 v23, 224, v30
    ds_read_b128 a[60:63], v23
Lg18:
    v_mfma_f32_32x32x16_bf16 v[240:255], v[108:111], v[84:87], v[240:255]
    s_waitcnt lgkmcnt(0)
    v_mfma_f32_32x32x16_bf16 v[128:143], v[112:115], v[88:91], v[128:143]
    s_add_u32 m0, s64, 20480
    s_nop 0
    buffer_load_dwordx4 v2, s[8:11], s56 offen offset:0  lds
    v_mfma_f32_32x32x16_bf16 v[192:207], v[112:115], v[92:95], v[192:207]
    buffer_load_dwordx4 v3, s[8:11], s56 offen offset:1024  lds
    s_waitcnt vmcnt(20)
    ds_read_b128 v[80:83], v14 offset:0
    ds_read_b128 v[84:87], v14 offset:4096
    v_mfma_f32_32x32x16_bf16 v[144:159], v[116:119], v[88:91], v[144:159]
    buffer_load_dwordx4 v4, s[8:11], s56 offen offset:2048  lds
    ds_read_b64_tr_b16 v[96:97], v8 offset:0
    ds_read_b64_tr_b16 v[98:99], v8 offset:1024
    v_mfma_f32_32x32x16_bf16 v[208:223], v[116:119], v[92:95], v[208:223]
    buffer_load_dwordx4 v5, s[8:11], s56 offen offset:3072  lds
    s_add_u32 s56, s56, 131072
    s_cmp_eq_u32 s56, s57
    s_cselect_b32 s56, s58, s56
    ds_read_b64_tr_b16 v[100:101], v9 offset:0
    ds_read_b64_tr_b16 v[102:103], v9 offset:1024
    v_mfma_f32_32x32x16_bf16 v[160:175], v[120:123], v[88:91], v[160:175]
    ds_read_b64_tr_b16 v[104:105], v10 offset:0
    ds_read_b64_tr_b16 v[106:107], v10 offset:1024
    v_mfma_f32_32x32x16_bf16 v[224:239], v[120:123], v[92:95], v[224:239]
    ds_read_b64_tr_b16 v[108:109], v11 offset:0
    ds_read_b64_tr_b16 v[110:111], v11 offset:1024
    v_mfma_f32_32x32x16_bf16 v[176:191], v[124:127], v[88:91], v[176:191]
    s_cmp_lg_u32 s5, 1
    s_cbranch_scc1 Lg19
    ds_read_b128 a[32:35], v30
    v_xor_b32 v17, 32, v30
    ds_read_b128 a[36:39], v17
    v_xor_b32 v18, 64, v30
    ds_read_b128 a[40:43], v18
    v_xor_b32 v19, 96, v30
    ds_read_b128 a[44:47], v19
Lg19:
    v_mfma_f32_32x32x16_bf16 v[240:255], v[124:127], v[92:95], v[240:255]
    s_cmp_lg_u32 s5, 0
    s_cbranch_scc1 Lg20
    s_mov_b32 m0, s65
    s_nop 0
    buffer_load_dwordx4 v24, s[20:23], s62 offen offset:0 nt lds
    buffer_load_dwordx4 v24, s[20:23], s62 offen offset:1024 nt lds
    buffer_load_dwordx4 v24, s[20:23], s62 offen offset:2048 nt lds
    buffer_load_dwordx4 v24, s[20:23], s62 offen offset:3072 nt lds
    s_add_u32 s79, s62, 4096
    s_add_u32 m0, s65, 4096
    s_nop 0
    buffer_load_dwordx4 v24, s[20:23], s79 offen offset:0 nt lds
    buffer_load_dwordx4 v24, s[20:23], s79 offen offset:1024 nt lds
    buffer_load_dwordx4 v24, s[20:23], s79 offen offset:2048 nt lds
    buffer_load_dwordx4 v24, s[20:23], s79 offen offset:3072 nt lds
Lg20:
    s_waitcnt lgkmcnt(0)
    v_mfma_f32_32x32x16_bf16 v[128:143], v[96:99], v[80:83], v[128:143]
    s_add_u32 m0, s64, 0
    s_nop 0
    buffer_load_dwordx4 v2, s[8:11], s56 offen offset:0  lds
    v_mfma_f32_32x32x16_bf16 v[192:207], v[96:99], v[84:87], v[192:207]
    buffer_load_dwordx4 v3, s[8:11], s56 offen offset:1024  lds
    s_waitcnt vmcnt(20)
    ds_read_b128 v[88:91], v15 offset:0
    ds_read_b128 v[92:95], v15 offset:4096
    v_mfma_f32_32x32x16_bf16 v[144:159], v[100:103], v[80:83], v[144:159]
    buffer_load_dwordx4 v4, s[8:11], s56 offen offset:2048  lds
    ds_read_b64_tr_b16 v[112:113], v8 offset:4096
    ds_read_b64_tr_b16 v[114:115], v8 offset:5120
    v_mfma_f32_32x32x16_bf16 v[208:223], v[100:103], v[84:87], v[208:223]
    buffer_load_dwordx4 v5, s[8:11], s56 offen offset:3072  lds
    s_add_u32 s56, s56, 131072
    ds_read_b64_tr_b16 v[116:117], v9 offset:4096
    ds_read_b64_tr_b16 v[118:119], v9 offset:5120
    v_mfma_f32_32x32x16_bf16 v[160:175], v[104:107], v[80:83], v[160:175]
    ds_read_b64_tr_b16 v[120:121], v10 offset:4096
    ds_read_b64_tr_b16 v[122:123], v10 offset:5120
    v_mfma_f32_32x32x16_bf16 v[224:239], v[104:107], v[84:87], v[224:239]
    ds_read_b64_tr_b16 v[124:125], v11 offset:4096
    ds_read_b64_tr_b16 v[126:127], v11 offset:5120
    v_mfma_f32_32x32x16_bf16 v[176:191], v[108:111], v[80:83], v[176:191]
    s_cmp_lg_u32 s5, 1
    s_cbranch_scc1 Lg21
    v_xor_b32 v20, 128, v30
    ds_read_b128 a[48:51], v20
    v_xor_b32 v21, 160, v30
    ds_read_b128 a[52:55], v21
    v_xor_b32 v22, 192, v30
    ds_read_b128 a[56:59], v22
    v_xor_b32 v23, 224, v30
    ds_read_b128 a[60:63], v23
Lg21:
    v_mfma_f32_32x32x16_bf16 v[240:255], v[108:111], v[84:87], v[240:255]
    s_waitcnt lgkmcnt(0)
    s_barrier
    v_mfma_f32_32x32x16_bf16 v[128:143], v[112:115], v[88:91], v[128:143]
    s_add_u32 m0, s64, 4096
    s_nop 0
    buffer_load_dwordx4 v2, s[8:11], s56 offen offset:0  lds
    v_mfma_f32_32x32x16_bf16 v[192:207], v[112:115], v[92:95], v[192:207]
    buffer_load_dwordx4 v3, s[8:11], s56 offen offset:1024  lds
    s_waitcnt vmcnt(20)
    ds_read_b128 v[80:83], v12 offset:8192
    ds_read_b128 v[84:87], v12 offset:12288
    v_mfma_f32_32x32x16_bf16 v[144:159], v[116:119], v[88:91], v[144:159]
    buffer_load_dwordx4 v4, s[8:11], s56 offen offset:2048  lds
    ds_read_b64_tr_b16 v[96:97], v8 offset:8192
    ds_read_b64_tr_b16 v[98:99], v8 offset:9216
    v_mfma_f32_32x32x16_bf16 v[208:223], v[116:119], v[92:95], v[208:223]
    buffer_load_dwordx4 v5, s[8:11], s56 offen offset:3072  lds
    s_add_u32 s56, s56, 131072
    ds_read_b64_tr_b16 v[100:101], v9 offset:8192
    ds_read_b64_tr_b16 v[102:103], v9 offset:9216
    v_mfma_f32_32x32x16_bf16 v[160:175], v[120:123], v[88:91], v[160:175]
    ds_read_b64_tr_b16 v[104:105], v10 offset:8192
    ds_read_b64_tr_b16 v[106:107], v10 offset:9216
    s_add_u32 m0, s66, 0
    s_nop 0
    buffer_load_dwordx4 v6, s[12:15], s59 offen offset:0  lds
    buffer_load_dwordx4 v7, s[12:15], s59 offen offset:1024  lds
    s_add_u32 s59, s59, 128
    s_cmp_eq_u32 s59, s60
    s_cselect_b32 s59, s61, s59
    v_mfma_f32_32x32x16_bf16 v[224:239], v[120:123], v[92:95], v[224:239]
    ds_read_b64_tr_b16 v[108:109], v11 offset:8192
    ds_read_b64_tr_b16 v[110:111], v11 offset:9216
    v_mfma_f32_32x32x16_bf16 v[176:191], v[124:127], v[88:91], v[176:191]
    s_cmp_lg_u32 s5, 2
    s_cbranch_scc1 Lg22
    ds_read_b128 a[32:35], v30
    v_xor_b32 v17, 32, v30
    ds_read_b128 a[36:39], v17
    v_xor_b32 v18, 64, v30
    ds_read_b128 a[40:43], v18
    v_xor_b32 v19, 96, v30
    ds_read_b128 a[44:47], v19
Lg22:
    v_mfma_f32_32x32x16_bf16 v[240:255], v[124:127], v[92:95], v[240:255]
    s_cmp_lg_u32 s5, 1
    s_cbranch_scc1 Lg23
    s_mov_b32 m0, s65
    s_nop 0
    buffer_load_dwordx4 v24, s[20:23], s62 offen offset:0 nt lds
    buffer_load_dwordx4 v24, s[20:23], s62 offen offset:1024 nt lds
    buffer_load_dwordx4 v24, s[20:23], s62 offen offset:2048 nt lds
    buffer_load_dwordx4 v24, s[20:23], s62 offen offset:3072 nt lds
    s_add_u32 s79, s62, 4096
    s_add_u32 m0, s65, 4096
    s_nop 0
    buffer_load_dwordx4 v24, s[20:23], s79 offen offset:0 nt lds
    buffer_load_dwordx4 v24, s[20:23], s79 offen offset:1024 nt lds
    buffer_load_dwordx4 v24, s[20:23], s79 offen offset:2048 nt lds
    buffer_load_dwordx4 v24, s[20:23], s79 offen offset:3072 nt lds
Lg23:
    s_waitcnt lgkmcnt(0)
    v_mfma_f32_32x32x16_bf16 v[128:143], v[96:99], v[80:83], v[128:143]
    s_add_u32 m0, s64, 8192
    s_nop 0
    buffer_load_dwordx4 v2, s[8:11], s56 offen offset:0  lds
    v_mfma_f32_32x32x16_bf16 v[192:207], v[96:99], v[84:87], v[192:207]
    buffer_load_dwordx4 v3, s[8:11], s56 offen offset:1024  lds
    s_waitcnt vmcnt(22)
    ds_read_b128 v[88:91], v13 offset:8192
    ds_read_b128 v[92:95], v13 offset:12288
    v_mfma_f32_32x32x16_bf16 v[144:159], v[100:103], v[80:83], v[144:159]
    buffer_load_dwordx4 v4, s[8:11], s56 offen offset:2048  lds
    ds_read_b64_tr_b16 v[112:113], v8 offset:12288
    ds_read_b64_tr_b16 v[114:115], v8 offset:13312
    v_mfma_f32_32x32x16_bf16 v[208:223], v[100:103], v[84:87], v[208:223]
    buffer_load_dwordx4 v5, s[8:11], s56 offen offset:3072  lds
    s_add_u32 s56, s56, 131072
    ds_read_b64_tr_b16 v[116:117], v9 offset:12288
    ds_read_b64_tr_b16 v[118:119], v9 offset:13312
    v_mfma_f32_32x32x16_bf16 v[160:175], v[104:107], v[80:83], v[160:175]
    ds_read_b64_tr_b16 v[120:121], v10 offset:12288
    ds_read_b64_tr_b16 v[122:123], v10 offset:13312
    v_mfma_f32_32x32x16_bf16 v[224:239], v[104:107], v[84:87], v[224:239]
    ds_read_b64_tr_b16 v[124:125], v11 offset:12288
    ds_read_b64_tr_b16 v[126:127], v11 offset:13312
    v_mfma_f32_32x32x16_bf16 v[176:191], v[108:111], v[80:83], v[176:191]
    s_cmp_lg_u32 s5, 2
    s_cbranch_scc1 Lg24
    v_xor_b32 v20, 128, v30
    ds_read_b128 a[48:51], v20
    v_xor_b32 v21, 160, v30
    ds_read_b128 a[52:55], v21
    v_xor_b32 v22, 192, v30
    ds_read_b128 a[56:59], v22
    v_xor_b32 v23, 224, v30
    ds_read_b128 a[60:63], v23
Lg24:
    v_mfma_f32_32x32x16_bf16 v[240:255], v[108:111], v[84:87], v[240:255]
    s_waitcnt lgkmcnt(0)
    v_mfma_f32_32x32x16_bf16 v[128:143], v[112:115], v[88:91], v[128:143]
    s_add_u32 m0, s64, 12288
    s_nop 0
    buffer_load_dwordx4 v2, s[8:11], s56 offen offset:0  lds
    v_mfma_f32_32x32x16_bf16 v[192:207], v[112:115], v[92:95], v[192:207]
    buffer_load_dwordx4 v3, s[8:11], s56 offen offset:1024  lds
    s_waitcnt vmcnt(20)
    ds_read_b128 v[80:83], v14 offset:8192
    ds_read_b128 v[84:87], v14 offset:12288
    v_mfma_f32_32x32x16_bf16 v[144:159], v[116:119], v[88:91], v[144:159]
    buffer_load_dwordx4 v4, s[8:11], s56 offen offset:2048  lds
    ds_read_b64_tr_b16 v[96:97], v8 offset:16384
    ds_read_b64_tr_b16 v[98:99], v8 offset:17408
    v_mfma_f32_32x32x16_bf16 v[208:223], v[116:119], v[92:95], v[208:223]
    buffer_load_dwordx4 v5, s[8:11], s56 offen offset:3072  lds
    s_add_u32 s56, s56, 131072
    s_cmp_eq_u32 s56, s57
    s_cselect_b32 s56, s58, s56
    ds_read_b64_tr_b16 v[100:101], v9 offset:16384
    ds_read_b64_tr_b16 v[102:103], v9 offset:17408
    v_mfma_f32_32x32x16_bf16 v[160:175], v[120:123], v[88:91], v[160:175]
    ds_read_b64_tr_b16 v[104:105], v10 offset:16384
    ds_read_b64_tr_b16 v[106:107], v10 offset:17408
    v_mfma_f32_32x32x16_bf16 v[224:239], v[120:123], v[92:95], v[224:239]
    ds_read_b64_tr_b16 v[108:109], v11 offset:16384
    ds_read_b64_tr_b16 v[110:111], v11 offset:17408
    v_mfma_f32_32x32x16_bf16 v[176:191], v[124:127], v[88:91], v[176:191]
    s_cmp_lg_u32 s5, 3
    s_cbranch_scc1 Lg25
    ds_read_b128 a[32:35], v30
    v_xor_b32 v17, 32, v30
    ds_read_b128 a[36:39], v17
    v_xor_b32 v18, 64, v30
    ds_read_b128 a[40:43], v18
    v_xor_b32 v19, 96, v30
    ds_read_b128 a[44:47], v19
Lg25:
    v_mfma_f32_32x32x16_bf16 v[240:255], v[124:127], v[92:95], v[240:255]
    s_cmp_lg_u32 s5, 2
    s_cbranch_scc1 Lg26
    s_mov_b32 m0, s65
    s_nop 0
    buffer_load_dwordx4 v24, s[20:23], s62 offen offset:0 nt lds
    buffer_load_dwordx4 v24, s[20:23], s62 offen offset:1024 nt lds
    buffer_load_dwordx4 v24, s[20:23], s62 offen offset:2048 nt lds
    buffer_load_dwordx4 v24, s[20:23], s62 offen offset:3072 nt lds
    s_add_u32 s79, s62, 4096
    s_add_u32 m0, s65, 4096
    s_nop 0
    buffer_load_dwordx4 v24, s[20:23], s79 offen offset:0 nt lds
    buffer_load_dwordx4 v24, s[20:23], s79 offen offset:1024 nt lds
    buffer_load_dwordx4 v24, s[20:23], s79 offen offset:2048 nt lds
    buffer_load_dwordx4 v24, s[20:23], s79 offen offset:3072 nt lds
Lg26:
    s_waitcnt lgkmcnt(0)
    v_mfma_f32_32x32x16_bf16 v[128:143], v[96:99], v[80:83], v[128:143]
    s_add_u32 m0, s64, 16384
    s_nop 0
    buffer_load_dwordx4 v2, s[8:11], s56 offen offset:0  lds
    v_mfma_f32_32x32x16_bf16 v[192:207], v[96:99], v[84:87], v[192:207]
    buffer_load_dwordx4 v3, s[8:11], s56 offen offset:1024  lds
    s_waitcnt vmcnt(20)
    ds_read_b128 v[88:91], v15 offset:8192
    ds_read_b128 v[92:95], v15 offset:12288
    v_mfma_f32_32x32x16_bf16 v[144:159], v[100:103], v[80:83], v[144:159]
    buffer_load_dwordx4 v4, s[8:11], s56 offen offset:2048  lds
    ds_read_b64_tr_b16 v[112:113], v8 offset:20480
    ds_read_b64_tr_b16 v[114:115], v8 offset:21504
    v_mfma_f32_32x32x16_bf16 v[208:223], v[100:103], v[84:87], v[208:223]
    buffer_load_dwordx4 v5, s[8:11], s56 offen offset:3072  lds
    s_add_u32 s56, s56, 131072
    ds_read_b64_tr_b16 v[116:117], v9 offset:20480
    ds_read_b64_tr_b16 v[118:119], v9 offset:21504
    v_mfma_f32_32x32x16_bf16 v[160:175], v[104:107], v[80:83], v[160:175]
    ds_read_b64_tr_b16 v[120:121], v10 offset:20480
    ds_read_b64_tr_b16 v[122:123], v10 offset:21504
    v_mfma_f32_32x32x16_bf16 v[224:239], v[104:107], v[84:87], v[224:239]
    ds_read_b64_tr_b16 v[124:125], v11 offset:20480
    ds_read_b64_tr_b16 v[126:127], v11 offset:21504
    v_mfma_f32_32x32x16_bf16 v[176:191], v[108:111], v[80:83], v[176:191]
    s_cmp_lg_u32 s5, 3
    s_cbranch_scc1 Lg27
    v_xor_b32 v20, 128, v30
    ds_read_b128 a[48:51], v20
    v_xor_b32 v21, 160, v30
    ds_read_b128 a[52:55], v21
    v_xor_b32 v22, 192, v30
    ds_read_b128 a[56:59], v22
    v_xor_b32 v23, 224, v30
    ds_read_b128 a[60:63], v23
Lg27:
    v_mfma_f32_32x32x16_bf16 v[240:255], v[108:111], v[84:87], v[240:255]
    s_waitcnt lgkmcnt(0)
    s_barrier
    v_mfma_f32_32x32x16_bf16 v[128:143], v[112:115], v[88:91], v[128:143]
    s_add_u32 m0, s64, 20480
    s_nop 0
    buffer_load_dwordx4 v2, s[8:11], s56 offen offset:0  lds
    v_mfma_f32_32x32x16_bf16 v[192:207], v[112:115], v[92:95], v[192:207]
    buffer_load_dwordx4 v3, s[8:11], s56 offen offset:1024  lds
    s_waitcnt vmcnt(20)
    ds_read_b128 v[80:83], v12 offset:16384
    ds_read_b128 v[84:87], v12 offset:20480
    v_mfma_f32_32x32x16_bf16 v[144:159], v[116:119], v[88:91], v[144:159]
    buffer_load_dwordx4 v4, s[8:11], s56 offen offset:2048  lds
    ds_read_b64_tr_b16 v[96:97], v8 offset:0
    ds_read_b64_tr_b16 v[98:99], v8 offset:1024
    v_mfma_f32_32x32x16_bf16 v[208:223], v[116:119], v[92:95], v[208:223]
    buffer_load_dwordx4 v5, s[8:11], s56 offen offset:3072  lds
    s_add_u32 s56, s56, 131072
    ds_read_b64_tr_b16 v[100:101], v9 offset:0
    ds_read_b64_tr_b16 v[102:103], v9 offset:1024
    v_mfma_f32_32x32x16_bf16 v[160:175], v[120:123], v[88:91], v[160:175]
    ds_read_b64_tr_b16 v[104:105], v10 offset:0
    ds_read_b64_tr_b16 v[106:107], v10 offset:1024
    s_add_u32 m0, s66, 8192
    s_nop 0
    buffer_load_dwordx4 v6, s[12:15], s59 offen offset:0  lds
    buffer_load_dwordx4 v7, s[12:15], s59 offen offset:1024  lds
    s_add_u32 s59, s59, 128
    s_cmp_eq_u32 s59, s60
    s_cselect_b32 s59, s61, s59
    v_mfma_f32_32x32x16_bf16 v[224:239], v[120:123], v[92:95], v[224:239]
    ds_read_b64_tr_b16 v[108:109], v11 offset:0
    ds_read_b64_tr_b16 v[110:111], v11 offset:1024
    v_mfma_f32_32x32x16_bf16 v[176:191], v[124:127], v[88:91], v[176:191]
    s_cmp_lg_u32 s5, 0
    s_cbranch_scc1 Lg28
    s_waitcnt lgkmcnt(7)
    ds_read_b64_tr_b16 a[64:65], v29 offset:0
    ds_read_b64_tr_b16 a[66:67], v29 offset:2048
    ds_read_b64_tr_b16 a[68:69], v29 offset:4096
    ds_read_b64_tr_b16 a[70:71], v29 offset:6144
    v_xor_b32 v17, 64, v29
    ds_read_b64_tr_b16 a[72:73], v17 offset:0
    ds_read_b64_tr_b16 a[74:75], v17 offset:2048
    ds_read_b64_tr_b16 a[76:77], v17 offset:4096
    ds_read_b64_tr_b16 a[78:79], v17 offset:6144
Lg28:
    v_mfma_f32_32x32x16_bf16 v[240:255], v[124:127], v[92:95], v[240:255]
    s_cmp_lg_u32 s5, 3
    s_cbranch_scc1 Lg29
    s_mov_b32 m0, s65
    s_nop 0
    buffer_load_dwordx4 v24, s[20:23], s62 offen offset:0 nt lds
    buffer_load_dwordx4 v24, s[20:23], s62 offen offset:1024 nt lds
    buffer_load_dwordx4 v24, s[20:23], s62 offen offset:2048 nt lds
    buffer_load_dwordx4 v24, s[20:23], s62 offen offset:3072 nt lds
    s_add_u32 s79, s62, 4096
    s_add_u32 m0, s65, 4096
    s_nop 0
    buffer_load_dwordx4 v24, s[20:23], s79 offen offset:0 nt lds
    buffer_load_dwordx4 v24, s[20:23], s79 offen offset:1024 nt lds
    buffer_load_dwordx4 v24, s[20:23], s79 offen offset:2048 nt lds
    buffer_load_dwordx4 v24, s[20:23], s79 offen offset:3072 nt lds
Lg29:
    s_waitcnt lgkmcnt(0)
    v_mfma_f32_32x32x16_bf16 v[128:143], v[96:99], v[80:83], v[128:143]
    s_add_u32 m0, s64, 0
    s_nop 0
    buffer_load_dwordx4 v2, s[8:11], s56 offen offset:0  lds
    v_mfma_f32_32x32x16_bf16 v[192:207], v[96:99], v[84:87], v[192:207]
    buffer_load_dwordx4 v3, s[8:11], s56 offen offset:1024  lds
    s_waitcnt vmcnt(22)
    ds_read_b128 v[88:91], v13 offset:16384
    ds_read_b128 v[92:95], v13 offset:20480
    v_mfma_f32_32x32x16_bf16 v[144:159], v[100:103], v[80:83], v[144:159]
    buffer_load_dwordx4 v4, s[8:11], s56 offen offset:2048  lds
    ds_read_b64_tr_b16 v[112:113], v8 offset:4096
    ds_read_b64_tr_b16 v[114:115], v8 offset:5120
    v_mfma_f32_32x32x16_bf16 v[208:223], v[100:103], v[84:87], v[208:223]
    buffer_load_dwordx4 v5, s[8:11], s56 offen offset:3072  lds
    s_add_u32 s56, s56, 131072
    ds_read_b64_tr_b16 v[116:117], v9 offset:4096
    ds_read_b64_tr_b16 v[118:119], v9 offset:5120
    v_mfma_f32_32x32x16_bf16 v[160:175], v[104:107], v[80:83], v[160:175]
    ds_read_b64_tr_b16 v[120:121], v10 offset:4096
    ds_read_b64_tr_b16 v[122:123], v10 offset:5120
    v_mfma_f32_32x32x16_bf16 v[224:239], v[104:107], v[84:87], v[224:239]
    ds_read_b64_tr_b16 v[124:125], v11 offset:4096
    ds_read_b64_tr_b16 v[126:127], v11 offset:5120
    v_mfma_f32_32x32x16_bf16 v[176:191], v[108:111], v[80:83], v[176:191]
    s_cmp_lg_u32 s5, 0
    s_cbranch_scc1 Lg30
    s_waitcnt lgkmcnt(7)
    v_xor_b32 v18, 128, v29
    ds_read_b64_tr_b16 a[80:81], v18 offset:0
    ds_read_b64_tr_b16 a[82:83], v18 offset:2048
    ds_read_b64_tr_b16 a[84:85], v18 offset:4096
    ds_read_b64_tr_b16 a[86:87], v18 offset:6144
    v_xor_b32 v19, 192, v29
    ds_read_b64_tr_b16 a[88:89], v19 offset:0
    ds_read_b64_tr_b16 a[90:91], v19 offset:2048
    ds_read_b64_tr_b16 a[92:93], v19 offset:4096
    ds_read_b64_tr_b16 a[94:95], v19 offset:6144
Lg30:
    v_mfma_f32_32x32x16_bf16 v[240:255], v[108:111], v[84:87], v[240:255]
    s_waitcnt lgkmcnt(0)
    v_mfma_f32_32x32x16_bf16 v[128:143], v[112:115], v[88:91], v[128:143]
    s_add_u32 m0, s64, 4096
    s_nop 0
    buffer_load_dwordx4 v2, s[8:11], s56 offen offset:0  lds
    v_mfma_f32_32x32x16_bf16 v[192:207], v[112:115], v[92:95], v[192:207]
    buffer_load_dwordx4 v3, s[8:11], s56 offen offset:1024  lds
    s_waitcnt vmcnt(20)
    ds_read_b128 v[80:83], v14 offset:16384
    ds_read_b128 v[84:87], v14 offset:20480
    v_mfma_f32_32x32x16_bf16 v[144:159], v[116:119], v[88:91], v[144:159]
    buffer_load_dwordx4 v4, s[8:11], s56 offen offset:2048  lds
    ds_read_b64_tr_b16 v[96:97], v8 offset:8192
    ds_read_b64_tr_b16 v[98:99], v8 offset:9216
    v_mfma_f32_32x32x16_bf16 v[208:223], v[116:119], v[92:95], v[208:223]
    buffer_load_dwordx4 v5, s[8:11], s56 offen offset:3072  lds
    s_add_u32 s56, s56, 131072
    s_cmp_eq_u32 s56, s57
    s_cselect_b32 s56, s58, s56
    ds_read_b64_tr_b16 v[100:101], v9 offset:8192
    ds_read_b64_tr_b16 v[102:103], v9 offset:9216
    v_mfma_f32_32x32x16_bf16 v[160:175], v[120:123], v[88:91], v[160:175]
    ds_read_b64_tr_b16 v[104:105], v10 offset:8192
    ds_read_b64_tr_b16 v[106:107], v10 offset:9216
    v_mfma_f32_32x32x16_bf16 v[224:239], v[120:123], v[92:95], v[224:239]
    ds_read_b64_tr_b16 v[108:109], v11 offset:8192
    ds_read_b64_tr_b16 v[110:111], v11 offset:9216
    v_mfma_f32_32x32x16_bf16 v[176:191], v[124:127], v[88:91], v[176:191]
    s_cmp_lg_u32 s5, 1
    s_cbranch_scc1 Lg31
    s_waitcnt lgkmcnt(7)
    ds_read_b64_tr_b16 a[64:65], v29 offset:0
    ds_read_b64_tr_b16 a[66:67], v29 offset:2048
    ds_read_b64_tr_b16 a[68:69], v29 offset:4096
    ds_read_b64_tr_b16 a[70:71], v29 offset:6144
    v_xor_b32 v17, 64, v29
    ds_read_b64_tr_b16 a[72:73], v17 offset:0
    ds_read_b64_tr_b16 a[74:75], v17 offset:2048
    ds_read_b64_tr_b16 a[76:77], v17 offset:4096
    ds_read_b64_tr_b16 a[78:79], v17 offset:6144
Lg31:
    v_mfma_f32_32x32x16_bf16 v[240:255], v[124:127], v[92:95], v[240:255]
    s_cmp_lg_u32 s5, 0
    s_cbranch_scc1 Lg32
    s_mov_b32 m0, s65
    s_nop 0
    buffer_load_dwordx4 v24, s[20:23], s63 offen offset:0 nt lds
    buffer_load_dwordx4 v24, s[20:23], s63 offen offset:1024 nt lds
    buffer_load_dwordx4 v24, s[20:23], s63 offen offset:2048 nt lds
    buffer_load_dwordx4 v24, s[20:23], s63 offen offset:3072 nt lds
    s_add_u32 s79, s63, 4096
    s_add_u32 m0, s65, 4096
    s_nop 0
    buffer_load_dwordx4 v24, s[20:23], s79 offen offset:0 nt lds
    buffer_load_dwordx4 v24, s[20:23], s79 offen offset:1024 nt lds
    buffer_load_dwordx4 v24, s[20:23], s79 offen offset:2048 nt lds
    buffer_load_dwordx4 v24, s[20:23], s79 offen offset:3072 nt lds
Lg32:
    s_waitcnt lgkmcnt(0)
    v_mfma_f32_32x32x16_bf16 v[128:143], v[96:99], v[80:83], v[128:143]
    s_add_u32 m0, s64, 8192
    s_nop 0
    buffer_load_dwordx4 v2, s[8:11], s56 offen offset:0  lds
    v_mfma_f32_32x32x16_bf16 v[192:207], v[96:99], v[84:87], v[192:207]
    buffer_load_dwordx4 v3, s[8:11], s56 offen offset:1024  lds
    s_waitcnt vmcnt(20)
    ds_read_b128 v[88:91], v15 offset:16384
    ds_read_b128 v[92:95], v15 offset:20480
    v_mfma_f32_32x32x16_bf16 v[144:159], v[100:103], v[80:83], v[144:159]
    buffer_load_dwordx4 v4, s[8:11], s56 offen offset:2048  lds
    ds_read_b64_tr_b16 v[112:113], v8 offset:12288
    ds_read_b64_tr_b16 v[114:115], v8 offset:13312
    v_mfma_f32_32x32x16_bf16 v[208:223], v[100:103], v[84:87], v[208:223]
    buffer_load_dwordx4 v5, s[8:11], s56 offen offset:3072  lds
    s_add_u32 s56, s56, 131072
    ds_read_b64_tr_b16 v[116:117], v9 offset:12288
    ds_read_b64_tr_b16 v[118:119], v9 offset:13312
    v_mfma_f32_32x32x16_bf16 v[160:175], v[104:107], v[80:83], v[160:175]
    ds_read_b64_tr_b16 v[120:121], v10 offset:12288
    ds_read_b64_tr_b16 v[122:123], v10 offset:13312
    v_mfma_f32_32x32x16_bf16 v[224:239], v[104:107], v[84:87], v[224:239]
    ds_read_b64_tr_b16 v[124:125], v11 offset:12288
    ds_read_b64_tr_b16 v[126:127], v11 offset:13312
    v_mfma_f32_32x32x16_bf16 v[176:191], v[108:111], v[80:83], v[176:191]
    s_cmp_lg_u32 s5, 1
    s_cbranch_scc1 Lg33
    s_waitcnt lgkmcnt(7)
    v_xor_b32 v18, 128, v29
    ds_read_b64_tr_b16 a[80:81], v18 offset:0
    ds_read_b64_tr_b16 a[82:83], v18 offset:2048
    ds_read_b64_tr_b16 a[84:85], v18 offset:4096
    ds_read_b64_tr_b16 a[86:87], v18 offset:6144
    v_xor_b32 v19, 192, v29
    ds_read_b64_tr_b16 a[88:89], v19 offset:0
    ds_read_b64_tr_b16 a[90:91], v19 offset:2048
    ds_read_b64_tr_b16 a[92:93], v19 offset:4096
    ds_read_b64_tr_b16 a[94:95], v19 offset:6144
Lg33:
    v_mfma_f32_32x32x16_bf16 v[240:255], v[108:111], v[84:87], v[240:255]
    s_waitcnt lgkmcnt(0)
    s_barrier
    v_mfma_f32_32x32x16_bf16 v[128:143], v[112:115], v[88:91], v[128:143]
    s_add_u32 m0, s64, 12288
    s_nop 0
    buffer_load_dwordx4 v2, s[8:11], s56 offen offset:0  lds
    v_mfma_f32_32x32x16_bf16 v[192:207], v[112:115], v[92:95], v[192:207]
    buffer_load_dwordx4 v3, s[8:11], s56 offen offset:1024  lds
    s_waitcnt vmcnt(20)
    ds_read_b128 v[80:83], v12 offset:24576
    ds_read_b128 v[84:87], v12 offset:28672
    v_mfma_f32_32x32x16_bf16 v[144:159], v[116:119], v[88:91], v[144:159]
    buffer_load_dwordx4 v4, s[8:11], s56 offen offset:2048  lds
    ds_read_b64_tr_b16 v[96:97], v8 offset:16384
    ds_read_b64_tr_b16 v[98:99], v8 offset:17408
    v_mfma_f32_32x32x16_bf16 v[208:223], v[116:119], v[92:95], v[208:223]
    buffer_load_dwordx4 v5, s[8:11], s56 offen offset:3072  lds
    s_add_u32 s56, s56, 131072
    ds_read_b64_tr_b16 v[100:101], v9 offset:16384
    ds_read_b64_tr_b16 v[102:103], v9 offset:17408
    v_mfma_f32_32x32x16_bf16 v[160:175], v[120:123], v[88:91], v[160:175]
    ds_read_b64_tr_b16 v[104:105], v10 offset:16384
    ds_read_b64_tr_b16 v[106:107], v10 offset:17408
    v_mfma_f32_32x32x16_bf16 v[224:239], v[120:123], v[92:95], v[224:239]
    ds_read_b64_tr_b16 v[108:109], v11 offset:16384
    ds_read_b64_tr_b16 v[110:111], v11 offset:17408
    v_mfma_f32_32x32x16_bf16 v[176:191], v[124:127], v[88:91], v[176:191]
    s_cmp_lg_u32 s5, 2
    s_cbranch_scc1 Lg34
    s_waitcnt lgkmcnt(7)
    ds_read_b64_tr_b16 a[64:65], v29 offset:0
    ds_read_b64_tr_b16 a[66:67], v29 offset:2048
    ds_read_b64_tr_b16 a[68:69], v29 offset:4096
    ds_read_b64_tr_b16 a[70:71], v29 offset:6144
    v_xor_b32 v17, 64, v29
    ds_read_b64_tr_b16 a[72:73], v17 offset:0
    ds_read_b64_tr_b16 a[74:75], v17 offset:2048
    ds_read_b64_tr_b16 a[76:77], v17 offset:4096
    ds_read_b64_tr_b16 a[78:79], v17 offset:6144
Lg34:
    v_mfma_f32_32x32x16_bf16 v[240:255], v[124:127], v[92:95], v[240:255]
    s_cmp_lg_u32 s5, 1
    s_cbranch_scc1 Lg35
    s_mov_b32 m0, s65
    s_nop 0
    buffer_load_dwordx4 v24, s[20:23], s63 offen offset:0 nt lds
    buffer_load_dwordx4 v24, s[20:23], s63 offen offset:1024 nt lds
    buffer_load_dwordx4 v24, s[20:23], s63 offen offset:2048 nt lds
    buffer_load_dwordx4 v24, s[20:23], s63 offen offset:3072 nt lds
    s_add_u32 s79, s63, 4096
    s_add_u32 m0, s65, 4096
    s_nop 0
    buffer_load_dwordx4 v24, s[20:23], s79 offen offset:0 nt lds
    buffer_load_dwordx4 v24, s[20:23], s79 offen offset:1024 nt lds
    buffer_load_dwordx4 v24, s[20:23], s79 offen offset:2048 nt lds
    buffer_load_dwordx4 v24, s[20:23], s79 offen offset:3072 nt lds
Lg35:
    s_waitcnt lgkmcnt(0)
    v_mfma_f32_32x32x16_bf16 v[128:143], v[96:99], v[80:83], v[128:143]
    s_add_u32 m0, s64, 16384
    s_nop 0
    buffer_load_dwordx4 v2, s[8:11], s56 offen offset:0  lds
    v_mfma_f32_32x32x16_bf16 v[192:207], v[96:99], v[84:87], v[192:207]
    buffer_load_dwordx4 v3, s[8:11], s56 offen offset:1024  lds
    s_waitcnt vmcnt(20)
    ds_read_b128 v[88:91], v13 offset:24576
    ds_read_b128 v[92:95], v13 offset:28672
    v_mfma_f32_32x32x16_bf16 v[144:159], v[100:103], v[80:83], v[144:159]
    buffer_load_dwordx4 v4, s[8:11], s56 offen offset:2048  lds
    ds_read_b64_tr_b16 v[112:113], v8 offset:20480
    ds_read_b64_tr_b16 v[114:115], v8 offset:21504
    v_mfma_f32_32x32x16_bf16 v[208:223], v[100:103], v[84:87], v[208:223]
    buffer_load_dwordx4 v5, s[8:11], s56 offen offset:3072  lds
    s_add_u32 s56, s56, 131072
    ds_read_b64_tr_b16 v[116:117], v9 offset:20480
    ds_read_b64_tr_b16 v[118:119], v9 offset:21504
    v_mfma_f32_32x32x16_bf16 v[160:175], v[104:107], v[80:83], v[160:175]
    ds_read_b64_tr_b16 v[120:121], v10 offset:20480
    ds_read_b64_tr_b16 v[122:123], v10 offset:21504
    v_mfma_f32_32x32x16_bf16 v[224:239], v[104:107], v[84:87], v[224:239]
    ds_read_b64_tr_b16 v[124:125], v11 offset:20480
    ds_read_b64_tr_b16 v[126:127], v11 offset:21504
    v_mfma_f32_32x32x16_bf16 v[176:191], v[108:111], v[80:83], v[176:191]
    s_cmp_lg_u32 s5, 2
    s_cbranch_scc1 Lg36
    s_waitcnt lgkmcnt(7)
    v_xor_b32 v18, 128, v29
    ds_read_b64_tr_b16 a[80:81], v18 offset:0
    ds_read_b64_tr_b16 a[82:83], v18 offset:2048
    ds_read_b64_tr_b16 a[84:85], v18 offset:4096
    ds_read_b64_tr_b16 a[86:87], v18 offset:6144
    v_xor_b32 v19, 192, v29
    ds_read_b64_tr_b16 a[88:89], v19 offset:0
    ds_read_b64_tr_b16 a[90:91], v19 offset:2048
    ds_read_b64_tr_b16 a[92:93], v19 offset:4096
    ds_read_b64_tr_b16 a[94:95], v19 offset:6144
Lg36:
    v_mfma_f32_32x32x16_bf16 v[240:255], v[108:111], v[84:87], v[240:255]
    s_waitcnt lgkmcnt(0)
    v_mfma_f32_32x32x16_bf16 v[128:143], v[112:115], v[88:91], v[128:143]
    s_add_u32 m0, s64, 20480
    s_nop 0
    buffer_load_dwordx4 v2, s[8:11], s56 offen offset:0  lds
    v_mfma_f32_32x32x16_bf16 v[192:207], v[112:115], v[92:95], v[192:207]
    buffer_load_dwordx4 v3, s[8:11], s56 offen offset:1024  lds
    s_waitcnt vmcnt(18)
    ds_read_b128 v[80:83], v14 offset:24576
    ds_read_b128 v[84:87], v14 offset:28672
    v_mfma_f32_32x32x16_bf16 v[144:159], v[116:119], v[88:91], v[144:159]
    buffer_load_dwordx4 v4, s[8:11], s56 offen offset:2048  lds
    ds_read_b64_tr_b16 v[96:97], v8 offset:0
    ds_read_b64_tr_b16 v[98:99], v8 offset:1024
    v_mfma_f32_32x32x16_bf16 v[208:223], v[116:119], v[92:95], v[208:223]
    buffer_load_dwordx4 v5, s[8:11], s56 offen offset:3072  lds
    s_add_u32 s56, s56, 131072
    s_cmp_eq_u32 s56, s57
    s_cselect_b32 s56, s58, s56
    ds_read_b64_tr_b16 v[100:101], v9 offset:0
    ds_read_b64_tr_b16 v[102:103], v9 offset:1024
    v_mfma_f32_32x32x16_bf16 v[160:175], v[120:123], v[88:91], v[160:175]
    ds_read_b64_tr_b16 v[104:105], v10 offset:0
    ds_read_b64_tr_b16 v[106:107], v10 offset:1024
    v_mfma_f32_32x32x16_bf16 v[224:239], v[120:123], v[92:95], v[224:239]
    ds_read_b64_tr_b16 v[108:109], v11 offset:0
    ds_read_b64_tr_b16 v[110:111], v11 offset:1024
    v_mfma_f32_32x32x16_bf16 v[176:191], v[124:127], v[88:91], v[176:191]
    s_cmp_lg_u32 s5, 3
    s_cbranch_scc1 Lg37
    s_waitcnt lgkmcnt(7)
    ds_read_b64_tr_b16 a[64:65], v29 offset:0
    ds_read_b64_tr_b16 a[66:67], v29 offset:2048
    ds_read_b64_tr_b16 a[68:69], v29 offset:4096
    ds_read_b64_tr_b16 a[70:71], v29 offset:6144
    v_xor_b32 v17, 64, v29
    ds_read_b64_tr_b16 a[72:73], v17 offset:0
    ds_read_b64_tr_b16 a[74:75], v17 offset:2048
    ds_read_b64_tr_b16 a[76:77], v17 offset:4096
    ds_read_b64_tr_b16 a[78:79], v17 offset:6144
Lg37:
    v_mfma_f32_32x32x16_bf16 v[240:255], v[124:127], v[92:95], v[240:255]
    s_cmp_lg_u32 s5, 2
    s_cbranch_scc1 Lg38
    s_mov_b32 m0, s65
    s_nop 0
    buffer_load_dwordx4 v24, s[20:23], s63 offen offset:0 nt lds
    buffer_load_dwordx4 v24, s[20:23], s63 offen offset:1024 nt lds
    buffer_load_dwordx4 v24, s[20:23], s63 offen offset:2048 nt lds
    buffer_load_dwordx4 v24, s[20:23], s63 offen offset:3072 nt lds
    s_add_u32 s79, s63, 4096
    s_add_u32 m0, s65, 4096
    s_nop 0
    buffer_load_dwordx4 v24, s[20:23], s79 offen offset:0 nt lds
    buffer_load_dwordx4 v24, s[20:23], s79 offen offset:1024 nt lds
    buffer_load_dwordx4 v24, s[20:23], s79 offen offset:2048 nt lds
    buffer_load_dwordx4 v24, s[20:23], s79 offen offset:3072 nt lds
Lg38:
    s_waitcnt lgkmcnt(0)
    v_mfma_f32_32x32x16_bf16 v[128:143], v[96:99], v[80:83], v[128:143]
    s_add_u32 m0, s64, 0
    s_nop 0
    buffer_load_dwordx4 v2, s[8:11], s56 offen offset:0  lds
    v_mfma_f32_32x32x16_bf16 v[192:207], v[96:99], v[84:87], v[192:207]
    buffer_load_dwordx4 v3, s[8:11], s56 offen offset:1024  lds
    s_waitcnt vmcnt(18)
    ds_read_b128 v[88:91], v15 offset:24576
    ds_read_b128 v[92:95], v15 offset:28672
    v_mfma_f32_32x32x16_bf16 v[144:159], v[100:103], v[80:83], v[144:159]
    buffer_load_dwordx4 v4, s[8:11], s56 offen offset:2048  lds
    ds_read_b64_tr_b16 v[112:113], v8 offset:4096
    ds_read_b64_tr_b16 v[114:115], v8 offset:5120
    v_mfma_f32_32x32x16_bf16 v[208:223], v[100:103], v[84:87], v[208:223]
    buffer_load_dwordx4 v5, s[8:11], s56 offen offset:3072  lds
    s_add_u32 s56, s56, 131072
    ds_read_b64_tr_b16 v[116:117], v9 offset:4096
    ds_read_b64_tr_b16 v[118:119], v9 offset:5120
    v_mfma_f32_32x32x16_bf16 v[160:175], v[104:107], v[80:83], v[160:175]
    ds_read_b64_tr_b16 v[120:121], v10 offset:4096
    ds_read_b64_tr_b16 v[122:123], v10 offset:5120
    v_mfma_f32_32x32x16_bf16 v[224:239], v[104:107], v[84:87], v[224:239]
    ds_read_b64_tr_b16 v[124:125], v11 offset:4096
    ds_read_b64_tr_b16 v[126:127], v11 offset:5120
    v_mfma_f32_32x32x16_bf16 v[176:191], v[108:111], v[80:83], v[176:191]
    s_cmp_lg_u32 s5, 3
    s_cbranch_scc1 Lg39
    s_waitcnt lgkmcnt(7)
    v_xor_b32 v18, 128, v29
    ds_read_b64_tr_b16 a[80:81], v18 offset:0
    ds_read_b64_tr_b16 a[82:83], v18 offset:2048
    ds_read_b64_tr_b16 a[84:85], v18 offset:4096
    ds_read_b64_tr_b16 a[86:87], v18 offset:6144
    v_xor_b32 v19, 192, v29
    ds_read_b64_tr_b16 a[88:89], v19 offset:0
    ds_read_b64_tr_b16 a[90:91], v19 offset:2048
    ds_read_b64_tr_b16 a[92:93], v19 offset:4096
    ds_read_b64_tr_b16 a[94:95], v19 offset:6144
Lg39:
    v_mfma_f32_32x32x16_bf16 v[240:255], v[108:111], v[84:87], v[240:255]
    s_waitcnt lgkmcnt(0)
    s_barrier
    v_mfma_f32_32x32x16_bf16 v[128:143], v[112:115], v[88:91], v[128:143]
    s_add_u32 m0, s64, 4096
    s_nop 0
    buffer_load_dwordx4 v2, s[8:11], s56 offen offset:0  lds
    v_mfma_f32_32x32x16_bf16 v[192:207], v[112:115], v[92:95], v[192:207]
    buffer_load_dwordx4 v3, s[8:11], s56 offen offset:1024  lds
    s_waitcnt vmcnt(18)
    ds_read_b128 v[80:83], v12 offset:0
    ds_read_b128 v[84:87], v12 offset:4096
    v_mfma_f32_32x32x16_bf16 v[144:159], v[116:119], v[88:91], v[144:159]
    buffer_load_dwordx4 v4, s[8:11], s56 offen offset:2048  lds
    ds_read_b64_tr_b16 v[96:97], v8 offset:8192
    ds_read_b64_tr_b16 v[98:99], v8 offset:9216
    v_mfma_f32_32x32x16_bf16 v[208:223], v[116:119], v[92:95], v[208:223]
    buffer_load_dwordx4 v5, s[8:11], s56 offen offset:3072  lds
    s_add_u32 s56, s56, 131072
    ds_read_b64_tr_b16 v[100:101], v9 offset:8192
    ds_read_b64_tr_b16 v[102:103], v9 offset:9216
    v_mfma_f32_32x32x16_bf16 v[160:175], v[120:123], v[88:91], v[160:175]
    ds_read_b64_tr_b16 v[104:105], v10 offset:8192
    ds_read_b64_tr_b16 v[106:107], v10 offset:9216
    v_mfma_f32_32x32x16_bf16 v[224:239], v[120:123], v[92:95], v[224:239]
    ds_read_b64_tr_b16 v[108:109], v11 offset:8192
    ds_read_b64_tr_b16 v[110:111], v11 offset:9216
    v_mfma_f32_32x32x16_bf16 v[176:191], v[124:127], v[88:91], v[176:191]
    v_mfma_f32_32x32x16_bf16 v[240:255], v[124:127], v[92:95], v[240:255]
    s_cmp_lg_u32 s5, 3
    s_cbranch_scc1 Lg40
    s_mov_b32 m0, s65
    s_nop 0
    buffer_load_dwordx4 v24, s[20:23], s63 offen offset:0 nt lds
    buffer_load_dwordx4 v24, s[20:23], s63 offen offset:1024 nt lds
    buffer_load_dwordx4 v24, s[20:23], s63 offen offset:2048 nt lds
    buffer_load_dwordx4 v24, s[20:23], s63 offen offset:3072 nt lds
    s_add_u32 s79, s63, 4096
    s_add_u32 m0, s65, 4096
    s_nop 0
    buffer_load_dwordx4 v24, s[20:23], s79 offen offset:0 nt lds
    buffer_load_dwordx4 v24, s[20:23], s79 offen offset:1024 nt lds
    buffer_load_dwordx4 v24, s[20:23], s79 offen offset:2048 nt lds
    buffer_load_dwordx4 v24, s[20:23], s79 offen offset:3072 nt lds
Lg40:
    s_waitcnt lgkmcnt(0)
    v_mfma_f32_32x32x16_bf16 v[128:143], v[96:99], v[80:83], v[128:143]
    s_add_u32 m0, s64, 8192
    s_nop 0
    buffer_load_dwordx4 v2, s[8:11], s56 offen offset:0  lds
    v_mfma_f32_32x32x16_bf16 v[192:207], v[96:99], v[84:87], v[192:207]
    buffer_load_dwordx4 v3, s[8:11], s56 offen offset:1024  lds
    s_waitcnt vmcnt(18)
    ds_read_b128 v[88:91], v13 offset:0
    ds_read_b128 v[92:95], v13 offset:4096
    v_mfma_f32_32x32x16_bf16 v[144:159], v[100:103], v[80:83], v[144:159]
    buffer_load_dwordx4 v4, s[8:11], s56 offen offset:2048  lds
    ds_read_b64_tr_b16 v[112:113], v8 offset:12288
    ds_read_b64_tr_b16 v[114:115], v8 offset:13312
    v_mfma_f32_32x32x16_bf16 v[208:223], v[100:103], v[84:87], v[208:223]
    buffer_load_dwordx4 v5, s[8:11], s56 offen offset:3072  lds
    s_add_u32 s56, s56, 131072
    ds_read_b64_tr_b16 v[116:117], v9 offset:12288
    ds_read_b64_tr_b16 v[118:119], v9 offset:13312
    v_mfma_f32_32x32x16_bf16 v[160:175], v[104:107], v[80:83], v[160:175]
    ds_read_b64_tr_b16 v[120:121], v10 offset:12288
    ds_read_b64_tr_b16 v[122:123], v10 offset:13312
    v_mfma_f32_32x32x16_bf16 v[224:239], v[104:107], v[84:87], v[224:239]
    ds_read_b64_tr_b16 v[124:125], v11 offset:12288
    ds_read_b64_tr_b16 v[126:127], v11 offset:13312
    v_mfma_f32_32x32x16_bf16 v[176:191], v[108:111], v[80:83], v[176:191]
    v_mfma_f32_32x32x16_bf16 v[240:255], v[108:111], v[84:87], v[240:255]
    s_waitcnt lgkmcnt(0)
    v_mfma_f32_32x32x16_bf16 v[128:143], v[112:115], v[88:91], v[128:143]
    s_add_u32 m0, s64, 12288
    s_nop 0
    buffer_load_dwordx4 v2, s[8:11], s56 offen offset:0  lds
    v_mfma_f32_32x32x16_bf16 v[192:207], v[112:115], v[92:95], v[192:207]
    buffer_load_dwordx4 v3, s[8:11], s56 offen offset:1024  lds
    s_waitcnt vmcnt(18)
    ds_read_b128 v[80:83], v14 offset:0
    ds_read_b128 v[84:87], v14 offset:4096
    v_mfma_f32_32x32x16_bf16 v[144:159], v[116:119], v[88:91], v[144:159]
    buffer_load_dwordx4 v4, s[8:11], s56 offen offset:2048  lds
    ds_read_b64_tr_b16 v[96:97], v8 offset:16384
    ds_read_b64_tr_b16 v[98:99], v8 offset:17408
    v_mfma_f32_32x32x16_bf16 v[208:223], v[116:119], v[92:95], v[208:223]
    buffer_load_dwordx4 v5, s[8:11], s56 offen offset:3072  lds
    s_add_u32 s56, s56, 131072
    s_cmp_eq_u32 s56, s57
    s_cselect_b32 s56, s58, s56
    ds_read_b64_tr_b16 v[100:101], v9 offset:16384
    ds_read_b64_tr_b16 v[102:103], v9 offset:17408
    v_mfma_f32_32x32x16_bf16 v[160:175], v[120:123], v[88:91], v[160:175]
    ds_read_b64_tr_b16 v[104:105], v10 offset:16384
    ds_read_b64_tr_b16 v[106:107], v10 offset:17408
    v_mfma_f32_32x32x16_bf16 v[224:239], v[120:123], v[92:95], v[224:239]
    ds_read_b64_tr_b16 v[108:109], v11 offset:16384
    ds_read_b64_tr_b16 v[110:111], v11 offset:17408
    v_mfma_f32_32x32x16_bf16 v[176:191], v[124:127], v[88:91], v[176:191]
    v_mfma_f32_32x32x16_bf16 v[240:255], v[124:127], v[92:95], v[240:255]
    s_waitcnt lgkmcnt(0)
    v_mfma_f32_32x32x16_bf16 v[128:143], v[96:99], v[80:83], v[128:143]
    v_lshrrev_b32 v2, 3, v0
    v_bfe_u32 v3, v0, 4, 1
    v_lshlrev_b32 v3, 2, v3
    v_and_b32 v4, 7, v0
    v_xor_b32 v3, v3, v4
    v_mul_u32_u24 v2, 1280, v2
    v_lshl_add_u32 v2, v3, 4, v2
    v_add_u32 v3, 9216, v2
    v_add_u32 v4, 18432, v2
    v_add_u32 v5, 27648, v2
    s_add_u32 s75, s68, s72
    s_add_u32 m0, s64, 16384
    s_nop 0
    buffer_load_dwordx4 v2, s[24:27], s75 offen offset:0  lds
    v_mfma_f32_32x32x16_bf16 v[192:207], v[96:99], v[84:87], v[192:207]
    buffer_load_dwordx4 v3, s[24:27], s75 offen offset:1024  lds
    s_waitcnt vmcnt(18)
    ds_read_b128 v[88:91], v15 offset:0
    ds_read_b128 v[92:95], v15 offset:4096
    v_mfma_f32_32x32x16_bf16 v[144:159], v[100:103], v[80:83], v[144:159]
    buffer_load_dwordx4 v4, s[24:27], s75 offen offset:2048  lds
    ds_read_b64_tr_b16 v[112:113], v8 offset:20480
    ds_read_b64_tr_b16 v[114:115], v8 offset:21504
    v_mfma_f32_32x32x16_bf16 v[208:223], v[100:103], v[84:87], v[208:223]
    buffer_load_dwordx4 v5, s[24:27], s75 offen offset:3072  lds
    ds_read_b64_tr_b16 v[116:117], v9 offset:20480
    ds_read_b64_tr_b16 v[118:119], v9 offset:21504
    v_mfma_f32_32x32x16_bf16 v[160:175], v[104:107], v[80:83], v[160:175]
    ds_read_b64_tr_b16 v[120:121], v10 offset:20480
    ds_read_b64_tr_b16 v[122:123], v10 offset:21504
    v_mfma_f32_32x32x16_bf16 v[224:239], v[104:107], v[84:87], v[224:239]
    ds_read_b64_tr_b16 v[124:125], v11 offset:20480
    ds_read_b64_tr_b16 v[126:127], v11 offset:21504
    v_mfma_f32_32x32x16_bf16 v[176:191], v[108:111], v[80:83], v[176:191]
    v_mfma_f32_32x32x16_bf16 v[240:255], v[108:111], v[84:87], v[240:255]
    s_waitcnt lgkmcnt(0)
    s_barrier
    v_mfma_f32_32x32x16_bf16 v[128:143], v[112:115], v[88:91], v[128:143]
    s_add_u32 s75, s75, 40960
    s_add_u32 m0, s64, 20480
    s_nop 0
    buffer_load_dwordx4 v2, s[24:27], s75 offen offset:0  lds
    v_mfma_f32_32x32x16_bf16 v[192:207], v[112:115], v[92:95], v[192:207]
    buffer_load_dwordx4 v3, s[24:27], s75 offen offset:1024  lds
    s_waitcnt vmcnt(18)
    ds_read_b128 v[80:83], v12 offset:8192
    ds_read_b128 v[84:87], v12 offset:12288
    v_mfma_f32_32x32x16_bf16 v[144:159], v[116:119], v[88:91], v[144:159]
    buffer_load_dwordx4 v4, s[24:27], s75 offen offset:2048  lds
    ds_read_b64_tr_b16 v[96:97], v8 offset:0
    ds_read_b64_tr_b16 v[98:99], v8 offset:1024
    v_mfma_f32_32x32x16_bf16 v[208:223], v[116:119], v[92:95], v[208:223]
    buffer_load_dwordx4 v5, s[24:27], s75 offen offset:3072  lds
    ds_read_b64_tr_b16 v[100:101], v9 offset:0
    ds_read_b64_tr_b16 v[102:103], v9 offset:1024
    v_mfma_f32_32x32x16_bf16 v[160:175], v[120:123], v[88:91], v[160:175]
    ds_read_b64_tr_b16 v[104:105], v10 offset:0
    ds_read_b64_tr_b16 v[106:107], v10 offset:1024
    v_mfma_f32_32x32x16_bf16 v[224:239], v[120:123], v[92:95], v[224:239]
    ds_read_b64_tr_b16 v[108:109], v11 offset:0
    ds_read_b64_tr_b16 v[110:111], v11 offset:1024
    v_mfma_f32_32x32x16_bf16 v[176:191], v[124:127], v[88:91], v[176:191]
    v_mfma_f32_32x32x16_bf16 v[240:255], v[124:127], v[92:95], v[240:255]
    s_waitcnt lgkmcnt(0)
    v_mfma_f32_32x32x16_bf16 v[128:143], v[96:99], v[80:83], v[128:143]
    s_add_u32 s75, s75, 40960
    s_add_u32 m0, s64, 0
    s_nop 0
    buffer_load_dwordx4 v2, s[24:27], s75 offen offset:0  lds
    v_mfma_f32_32x32x16_bf16 v[192:207], v[96:99], v[84:87], v[192:207]
    buffer_load_dwordx4 v3, s[24:27], s75 offen offset:1024  lds
    s_waitcnt vmcnt(18)
    ds_read_b128 v[88:91], v13 offset:8192
    ds_read_b128 v[92:95], v13 offset:12288
    v_mfma_f32_32x32x16_bf16 v[144:159], v[100:103], v[80:83], v[144:159]
    buffer_load_dwordx4 v4, s[24:27], s75 offen offset:2048  lds
    ds_read_b64_tr_b16 v[112:113], v8 offset:4096
    ds_read_b64_tr_b16 v[114:115], v8 offset:5120
    v_mfma_f32_32x32x16_bf16 v[208:223], v[100:103], v[84:87], v[208:223]
    buffer_load_dwordx4 v5, s[24:27], s75 offen offset:3072  lds
    ds_read_b64_tr_b16 v[116:117], v9 offset:4096
    ds_read_b64_tr_b16 v[118:119], v9 offset:5120
    v_mfma_f32_32x32x16_bf16 v[160:175], v[104:107], v[80:83], v[160:175]
    ds_read_b64_tr_b16 v[120:121], v10 offset:4096
    ds_read_b64_tr_b16 v[122:123], v10 offset:5120
    v_mfma_f32_32x32x16_bf16 v[224:239], v[104:107], v[84:87], v[224:239]
    ds_read_b64_tr_b16 v[124:125], v11 offset:4096
    ds_read_b64_tr_b16 v[126:127], v11 offset:5120
    v_mfma_f32_32x32x16_bf16 v[176:191], v[108:111], v[80:83], v[176:191]
    v_mfma_f32_32x32x16_bf16 v[240:255], v[108:111], v[84:87], v[240:255]
    s_waitcnt lgkmcnt(0)
    v_mfma_f32_32x32x16_bf16 v[128:143], v[112:115], v[88:91], v[128:143]
    s_add_u32 s75, s75, 40960
    s_add_u32 m0, s64, 4096
    s_nop 0
    buffer_load_dwordx4 v2, s[24:27], s75 offen offset:0  lds
    v_mfma_f32_32x32x16_bf16 v[192:207], v[112:115], v[92:95], v[192:207]
    buffer_load_dwordx4 v3, s[24:27], s75 offen offset:1024  lds
    s_waitcnt vmcnt(18)
    ds_read_b128 v[80:83], v14 offset:8192
    ds_read_b128 v[84:87], v14 offset:12288
    v_mfma_f32_32x32x16_bf16 v[144:159], v[116:119], v[88:91], v[144:159]
    buffer_load_dwordx4 v4, s[24:27], s75 offen offset:2048  lds
    ds_read_b64_tr_b16 v[96:97], v8 offset:8192
    ds_read_b64_tr_b16 v[98:99], v8 offset:9216
    v_mfma_f32_32x32x16_bf16 v[208:223], v[116:119], v[92:95], v[208:223]
    buffer_load_dwordx4 v5, s[24:27], s75 offen offset:3072  lds
    ds_read_b64_tr_b16 v[100:101], v9 offset:8192
    ds_read_b64_tr_b16 v[102:103], v9 offset:9216
    v_mfma_f32_32x32x16_bf16 v[160:175], v[120:123], v[88:91], v[160:175]
    ds_read_b64_tr_b16 v[104:105], v10 offset:8192
    ds_read_b64_tr_b16 v[106:107], v10 offset:9216
    v_mfma_f32_32x32x16_bf16 v[224:239], v[120:123], v[92:95], v[224:239]
    ds_read_b64_tr_b16 v[108:109], v11 offset:8192
    ds_read_b64_tr_b16 v[110:111], v11 offset:9216
    v_mfma_f32_32x32x16_bf16 v[176:191], v[124:127], v[88:91], v[176:191]
    v_mfma_f32_32x32x16_bf16 v[240:255], v[124:127], v[92:95], v[240:255]
    s_waitcnt lgkmcnt(0)
    v_mfma_f32_32x32x16_bf16 v[128:143], v[96:99], v[80:83], v[128:143]
    s_add_u32 s75, s69, s72
    s_add_u32 m0, s64, 8192
    s_nop 0
    buffer_load_dwordx4 v2, s[24:27], s75 offen offset:0  lds
    v_mov_b32 v6, v31
    v_xor_b32 v7, 64, v31
    ds_read_b64_tr_b16 a[96:97], v29 offset:0
    ds_read_b64_tr_b16 a[98:99], v29 offset:2048
    v_mfma_f32_32x32x16_bf16 v[192:207], v[96:99], v[84:87], v[192:207]
    buffer_load_dwordx4 v3, s[24:27], s75 offen offset:1024  lds
    s_waitcnt vmcnt(18)
    ds_read_b128 v[88:91], v15 offset:8192
    ds_read_b128 v[92:95], v15 offset:12288
    v_mfma_f32_32x32x16_bf16 v[144:159], v[100:103], v[80:83], v[144:159]
    buffer_load_dwordx4 v4, s[24:27], s75 offen offset:2048  lds
    ds_read_b64_tr_b16 v[112:113], v8 offset:12288
    ds_read_b64_tr_b16 v[114:115], v8 offset:13312
    v_mfma_f32_32x32x16_bf16 v[208:223], v[100:103], v[84:87], v[208:223]
    buffer_load_dwordx4 v5, s[24:27], s75 offen offset:3072  lds
    ds_read_b64_tr_b16 v[116:117], v9 offset:12288
    ds_read_b64_tr_b16 v[118:119], v9 offset:13312
    v_mfma_f32_32x32x16_bf16 v[160:175], v[104:107], v[80:83], v[160:175]
    ds_read_b64_tr_b16 v[120:121], v10 offset:12288
    ds_read_b64_tr_b16 v[122:123], v10 offset:13312
    v_mfma_f32_32x32x16_bf16 v[224:239], v[104:107], v[84:87], v[224:239]
    ds_read_b64_tr_b16 v[124:125], v11 offset:12288
    ds_read_b64_tr_b16 v[126:127], v11 offset:13312
    v_mfma_f32_32x32x16_bf16 v[176:191], v[108:111], v[80:83], v[176:191]
    ds_read_b64_tr_b16 a[100:101], v29 offset:4096
    ds_read_b64_tr_b16 a[102:103], v29 offset:6144
    v_xor_b32 v17, 64, v29
    ds_read_b64_tr_b16 a[104:105], v17 offset:0
    v_mfma_f32_32x32x16_bf16 v[240:255], v[108:111], v[84:87], v[240:255]
    s_waitcnt lgkmcnt(14)
    ds_read_b64_tr_b16 a[106:107], v17 offset:2048
    s_waitcnt lgkmcnt(14)
    ds_read_b64_tr_b16 a[108:109], v17 offset:4096
    s_waitcnt lgkmcnt(14)
    ds_read_b64_tr_b16 a[110:111], v17 offset:6144
    s_waitcnt lgkmcnt(6)
    v_mfma_f32_32x32x16_bf16 v[128:143], v[112:115], v[88:91], v[128:143]
    s_add_u32 s75, s75, 40960
    s_add_u32 m0, s64, 12288
    s_nop 0
    buffer_load_dwordx4 v2, s[24:27], s75 offen offset:0  lds
    v_xor_b32 v18, 128, v29
    ds_read_b64_tr_b16 a[112:113], v18 offset:0
    ds_read_b64_tr_b16 a[114:115], v18 offset:2048
    v_mfma_f32_32x32x16_bf16 v[144:159], v[116:119], v[88:91], v[144:159]
    buffer_load_dwordx4 v3, s[24:27], s75 offen offset:1024  lds
    ds_read_b64_tr_b16 a[116:117], v18 offset:4096
    ds_read_b64_tr_b16 a[118:119], v18 offset:6144
    v_xor_b32 v19, 192, v29
    ds_read_b64_tr_b16 a[120:121], v19 offset:0
    v_mfma_f32_32x32x16_bf16 v[160:175], v[120:123], v[88:91], v[160:175]
    buffer_load_dwordx4 v4, s[24:27], s75 offen offset:2048  lds
    ds_read_b64_tr_b16 a[122:123], v19 offset:2048
    ds_read_b64_tr_b16 a[124:125], v19 offset:4096
    ds_read_b64_tr_b16 a[126:127], v19 offset:6144
    v_mfma_f32_32x32x16_bf16 v[176:191], v[124:127], v[88:91], v[176:191]
    buffer_load_dwordx4 v5, s[24:27], s75 offen offset:3072  lds
    v_cvt_pk_bf16_f32 v32, v128, v129
    v_cvt_pk_bf16_f32 v33, v130, v131
    v_cvt_pk_bf16_f32 v34, v132, v133
    v_cvt_pk_bf16_f32 v35, v134, v135
    v_cvt_pk_bf16_f32 v36, v136, v137
    v_mfma_f32_32x32x16_bf16 v[192:207], v[112:115], v[92:95], v[192:207]
    v_cvt_pk_bf16_f32 v37, v138, v139
    v_cvt_pk_bf16_f32 v38, v140, v141
    v_cvt_pk_bf16_f32 v39, v142, v143
    v_cvt_pk_bf16_f32 v40, v144, v145
    v_cvt_pk_bf16_f32 v41, v146, v147
    v_cvt_pk_bf16_f32 v42, v148, v149
    v_cvt_pk_bf16_f32 v43, v150, v151
    v_mfma_f32_32x32x16_bf16 v[208:223], v[116:119], v[92:95], v[208:223]
    v_cvt_pk_bf16_f32 v44, v152, v153
    v_cvt_pk_bf16_f32 v45, v154, v155
    v_cvt_pk_bf16_f32 v46, v156, v157
    v_cvt_pk_bf16_f32 v47, v158, v159
    v_cvt_pk_bf16_f32 v48, v160, v161
    v_cvt_pk_bf16_f32 v49, v162, v163
    v_cvt_pk_bf16_f32 v50, v164, v165
    v_mfma_f32_32x32x16_bf16 v[224:239], v[120:123], v[92:95], v[224:239]
    v_cvt_pk_bf16_f32 v51, v166, v167
    v_cvt_pk_bf16_f32 v52, v168, v169
    v_cvt_pk_bf16_f32 v53, v170, v171
    v_cvt_pk_bf16_f32 v54, v172, v173
    v_cvt_pk_bf16_f32 v55, v174, v175
    v_cvt_pk_bf16_f32 v56, v176, v177
    v_cvt_pk_bf16_f32 v57, v178, v179
    v_mfma_f32_32x32x16_bf16 v[240:255], v[124:127], v[92:95], v[240:255]
    v_cvt_pk_bf16_f32 v58, v180, v181
    v_cvt_pk_bf16_f32 v59, v182, v183
    v_cvt_pk_bf16_f32 v60, v184, v185
    v_cvt_pk_bf16_f32 v61, v186, v187
    v_cvt_pk_bf16_f32 v62, v188, v189
    v_cvt_pk_bf16_f32 v63, v190, v191
    v_mfma_f32_32x32x16_bf16 v[96:111], a[0:3], v[32:35], 0
    v_cvt_pk_bf16_f32 v64, v192, v193
    v_cvt_pk_bf16_f32 v65, v194, v195
    v_cvt_pk_bf16_f32 v66, v196, v197
    v_cvt_pk_bf16_f32 v67, v198, v199
    s_waitcnt vmcnt(20)
    ds_read_b64_tr_b16 a[128:129], v6 offset:16384
    s_waitcnt lgkmcnt(14)
    ds_read_b64_tr_b16 a[130:131], v6 offset:17408
    v_mfma_f32_32x32x16_bf16 v[96:111], a[4:7], v[36:39], v[96:111]
    v_cvt_pk_bf16_f32 v68, v200, v201
    v_cvt_pk_bf16_f32 v69, v202, v203
    v_cvt_pk_bf16_f32 v70, v204, v205
    v_cvt_pk_bf16_f32 v71, v206, v207
    s_waitcnt lgkmcnt(14)
    ds_read_b64_tr_b16 a[132:133], v7 offset:16384
    s_waitcnt lgkmcnt(14)
    ds_read_b64_tr_b16 a[134:135], v7 offset:17408
    v_mfma_f32_32x32x16_bf16 v[96:111], a[8:11], v[40:43], v[96:111]
    v_cvt_pk_bf16_f32 v72, v208, v209
    v_cvt_pk_bf16_f32 v73, v210, v211
    v_cvt_pk_bf16_f32 v74, v212, v213
    v_cvt_pk_bf16_f32 v75, v214, v215
    s_waitcnt lgkmcnt(14)
    ds_read_b64_tr_b16 a[136:137], v6 offset:18432
    s_waitcnt lgkmcnt(14)
    ds_read_b64_tr_b16 a[138:139], v6 offset:19456
    v_mfma_f32_32x32x16_bf16 v[96:111], a[12:15], v[44:47], v[96:111]
    v_cvt_pk_bf16_f32 v76, v216, v217
    v_cvt_pk_bf16_f32 v77, v218, v219
    v_cvt_pk_bf16_f32 v78, v220, v221
    v_cvt_pk_bf16_f32 v79, v222, v223
    s_waitcnt lgkmcnt(14)
    ds_read_b64_tr_b16 a[140:141], v7 offset:18432
    s_waitcnt lgkmcnt(14)
    ds_read_b64_tr_b16 a[142:143], v7 offset:19456
    v_mfma_f32_32x32x16_bf16 v[96:111], a[16:19], v[48:51], v[96:111]
    v_cvt_pk_bf16_f32 v80, v224, v225
    v_cvt_pk_bf16_f32 v81, v226, v227
    v_cvt_pk_bf16_f32 v82, v228, v229
    v_cvt_pk_bf16_f32 v83, v230, v231
    s_waitcnt vmcnt(16)
    s_waitcnt lgkmcnt(14)
    ds_read_b64_tr_b16 a[144:145], v6 offset:20480
    s_waitcnt lgkmcnt(14)
    ds_read_b64_tr_b16 a[146:147], v6 offset:21504
    v_mfma_f32_32x32x16_bf16 v[96:111], a[20:23], v[52:55], v[96:111]
    v_cvt_pk_bf16_f32 v84, v232, v233
    v_cvt_pk_bf16_f32 v85, v234, v235
    v_cvt_pk_bf16_f32 v86, v236, v237
    v_cvt_pk_bf16_f32 v87, v238, v239
    s_waitcnt lgkmcnt(14)
    ds_read_b64_tr_b16 a[148:149], v7 offset:20480
    s_waitcnt lgkmcnt(14)
    ds_read_b64_tr_b16 a[150:151], v7 offset:21504
    v_mfma_f32_32x32x16_bf16 v[96:111], a[24:27], v[56:59], v[96:111]
    v_cvt_pk_bf16_f32 v88, v240, v241
    v_cvt_pk_bf16_f32 v89, v242, v243
    v_cvt_pk_bf16_f32 v90, v244, v245
    v_cvt_pk_bf16_f32 v91, v246, v247
    s_waitcnt lgkmcnt(14)
    ds_read_b64_tr_b16 a[152:153], v6 offset:22528
    s_waitcnt lgkmcnt(14)
    ds_read_b64_tr_b16 a[154:155], v6 offset:23552
    v_mfma_f32_32x32x16_bf16 v[96:111], a[28:31], v[60:63], v[96:111]
    v_cvt_pk_bf16_f32 v92, v248, v249
    v_cvt_pk_bf16_f32 v93, v250, v251
    v_cvt_pk_bf16_f32 v94, v252, v253
    v_cvt_pk_bf16_f32 v95, v254, v255
    s_waitcnt lgkmcnt(14)
    ds_read_b64_tr_b16 a[156:157], v7 offset:22528
    s_waitcnt lgkmcnt(14)
    ds_read_b64_tr_b16 a[158:159], v7 offset:23552
    v_lshlrev_b32 v11, 4, v0
    s_lshl_b32 s79, s32, 13
    s_add_u32 s79, s79, 98304
    v_add_u32 v11, s79, v11
    v_mfma_f32_32x32x16_bf16 v[16:31], a[32:35], v[64:67], 0
    s_waitcnt lgkmcnt(8)
    s_add_u32 s75, s75, 40960
    s_add_u32 m0, s64, 16384
    s_nop 0
    buffer_load_dwordx4 v2, s[24:27], s75 offen offset:0  lds
    buffer_load_dwordx4 v3, s[24:27], s75 offen offset:1024  lds
    buffer_load_dwordx4 v4, s[24:27], s75 offen offset:2048  lds
    buffer_load_dwordx4 v5, s[24:27], s75 offen offset:3072  lds
    v_mfma_f32_32x32x16_bf16 v[16:31], a[36:39], v[68:71], v[16:31]
    s_waitcnt vmcnt(16)
    ds_read_b64_tr_b16 a[160:161], v6 offset:0
    ds_read_b64_tr_b16 a[162:163], v6 offset:1024
    ds_read_b64_tr_b16 a[164:165], v7 offset:0
    ds_read_b64_tr_b16 a[166:167], v7 offset:1024
    ds_read_b64_tr_b16 a[168:169], v6 offset:2048
    ds_read_b64_tr_b16 a[170:171], v6 offset:3072
    ds_read_b64_tr_b16 a[172:173], v7 offset:2048
    s_waitcnt lgkmcnt(14)
    ds_read_b64_tr_b16 a[174:175], v7 offset:3072
    v_mfma_f32_32x32x16_bf16 v[16:31], a[40:43], v[72:75], v[16:31]
    v_max3_f32 v8, v96, v97, v98
    v_max3_f32 v9, v99, v100, v101
    v_max3_f32 v8, v8, v102, v103
    v_max3_f32 v9, v9, v104, v105
    v_max3_f32 v8, v8, v106, v107
    v_max3_f32 v9, v9, v108, v109
    v_mfma_f32_32x32x16_bf16 v[16:31], a[44:47], v[76:79], v[16:31]
    v_max3_f32 v8, v8, v110, v111
    v_max_f32 v8, v8, v9
    v_mov_b32 v9, v8
    s_nop 1
    v_permlane32_swap_b32 v8, v9
    s_waitcnt lgkmcnt(8)
    s_add_u32 s75, s75, 40960
    s_add_u32 m0, s64, 20480
    s_nop 0
    buffer_load_dwordx4 v2, s[24:27], s75 offen offset:0  lds
    v_mfma_f32_32x32x16_bf16 v[16:31], a[48:51], v[80:83], v[16:31]
    buffer_load_dwordx4 v3, s[24:27], s75 offen offset:1024  lds
    buffer_load_dwordx4 v4, s[24:27], s75 offen offset:2048  lds
    buffer_load_dwordx4 v5, s[24:27], s75 offen offset:3072  lds
    v_max_f32 v8, v8, v9
    v_mul_f32 v8, s80, v8
    v_fma_f32 v96, v96, s80, -v8
    v_mfma_f32_32x32x16_bf16 v[16:31], a[52:55], v[84:87], v[16:31]
    v_fma_f32 v97, v97, s80, -v8
    v_fma_f32 v98, v98, s80, -v8
    v_fma_f32 v99, v99, s80, -v8
    v_fma_f32 v100, v100, s80, -v8
    v_fma_f32 v101, v101, s80, -v8
    v_fma_f32 v102, v102, s80, -v8
    v_mfma_f32_32x32x16_bf16 v[16:31], a[56:59], v[88:91], v[16:31]
    v_fma_f32 v103, v103, s80, -v8
    v_fma_f32 v104, v104, s80, -v8
    v_fma_f32 v105, v105, s80, -v8
    v_fma_f32 v106, v106, s80, -v8
    v_fma_f32 v107, v107, s80, -v8
    v_fma_f32 v108, v108, s80, -v8
    v_mfma_f32_32x32x16_bf16 v[16:31], a[60:63], v[92:95], v[16:31]
    s_waitcnt lgkmcnt(0)
    s_add_u32 s75, s70, s72
    s_add_u32 m0, s64, 0
    s_nop 0
    buffer_load_dwordx4 v2, s[24:27], s75 offen offset:0  lds
    buffer_load_dwordx4 v3, s[24:27], s75 offen offset:1024  lds
    buffer_load_dwordx4 v4, s[24:27], s75 offen offset:2048  lds
    buffer_load_dwordx4 v5, s[24:27], s75 offen offset:3072  lds
    v_fma_f32 v109, v109, s80, -v8
    v_fma_f32 v110, v110, s80, -v8
    v_fma_f32 v111, v111, s80, -v8
    v_exp_f32 v96, v96
    v_exp_f32 v97, v97
    v_exp_f32 v98, v98
    v_exp_f32 v99, v99
    v_exp_f32 v100, v100
    v_exp_f32 v101, v101
    v_exp_f32 v102, v102
    v_exp_f32 v103, v103
    v_exp_f32 v104, v104
    v_exp_f32 v105, v105
    v_exp_f32 v106, v106
    v_exp_f32 v107, v107
    s_waitcnt vmcnt(20)
    ds_read_b64_tr_b16 a[176:177], v6 offset:4096
    ds_read_b64_tr_b16 a[178:179], v6 offset:5120
    ds_read_b64_tr_b16 a[180:181], v7 offset:4096
    ds_read_b64_tr_b16 a[182:183], v7 offset:5120
    ds_read_b64_tr_b16 a[184:185], v6 offset:6144
    ds_read_b64_tr_b16 a[186:187], v6 offset:7168
    ds_read_b64_tr_b16 a[188:189], v7 offset:6144
    ds_read_b64_tr_b16 a[190:191], v7 offset:7168
    v_exp_f32 v108, v108
    v_exp_f32 v109, v109
    v_exp_f32 v110, v110
    v_exp_f32 v111, v111
    v_add_f32 v10, v96, v97
    v_add_f32 v9, v98, v99
    v_add_f32 v10, v10, v100
    v_add_f32 v9, v9, v101
    v_add_f32 v10, v10, v102
    v_add_f32 v9, v9, v103
    v_add_f32 v10, v10, v104
    v_add_f32 v9, v9, v105
    v_add_f32 v10, v10, v106
    v_add_f32 v9, v9, v107
    v_add_f32 v10, v10, v108
    v_add_f32 v9, v9, v109
    v_add_f32 v10, v10, v110
    v_add_f32 v9, v9, v111
    v_add_f32 v10, v10, v9
    v_mov_b32 v9, v10
    s_waitcnt lgkmcnt(0)
    s_add_u32 s75, s75, 40960
    s_add_u32 m0, s64, 4096
    s_nop 0
    buffer_load_dwordx4 v2, s[24:27], s75 offen offset:0  lds
    buffer_load_dwordx4 v3, s[24:27], s75 offen offset:1024  lds
    buffer_load_dwordx4 v4, s[24:27], s75 offen offset:2048  lds
    buffer_load_dwordx4 v5, s[24:27], s75 offen offset:3072  lds
    v_permlane32_swap_b32 v10, v9
    v_add_f32 v10, v10, v9
    v_rcp_f32 v10, v10
    s_nop 0
    v_mul_f32 v96, v96, v10
    v_mul_f32 v97, v97, v10
    v_mul_f32 v98, v98, v10
    v_mul_f32 v99, v99, v10
    v_mul_f32 v100, v100, v10
    v_mul_f32 v101, v101, v10
    v_mul_f32 v102, v102, v10
    s_waitcnt vmcnt(20)
    ds_read_b64_tr_b16 v[32:33], v6 offset:8192
    ds_read_b64_tr_b16 v[34:35], v6 offset:9216
    ds_read_b64_tr_b16 v[36:37], v7 offset:8192
    ds_read_b64_tr_b16 v[38:39], v7 offset:9216
    ds_read_b64_tr_b16 v[40:41], v6 offset:10240
    ds_read_b64_tr_b16 v[42:43], v6 offset:11264
    ds_read_b64_tr_b16 v[44:45], v7 offset:10240
    ds_read_b64_tr_b16 v[46:47], v7 offset:11264
    v_mul_f32 v103, v103, v10
    v_mul_f32 v104, v104, v10
    v_mul_f32 v105, v105, v10
    v_mul_f32 v106, v106, v10
    v_mul_f32 v107, v107, v10
    v_mul_f32 v108, v108, v10
    v_mul_f32 v109, v109, v10
    v_mul_f32 v110, v110, v10
    v_mul_f32 v111, v111, v10
    v_cvt_pk_bf16_f32 v112, v96, v97
    v_cvt_pk_bf16_f32 v113, v98, v99
    v_cvt_pk_bf16_f32 v114, v100, v101
    v_cvt_pk_bf16_f32 v115, v102, v103
    v_cvt_pk_bf16_f32 v116, v104, v105
    v_cvt_pk_bf16_f32 v117, v106, v107
    v_cvt_pk_bf16_f32 v118, v108, v109
    v_cvt_pk_bf16_f32 v119, v110, v111
    v_mfma_f32_32x32x16_bf16 v[128:143], a[64:67], v[112:115], 0
    s_waitcnt lgkmcnt(0)
    s_add_u32 s75, s75, 40960
    s_add_u32 m0, s64, 8192
    s_nop 0
    buffer_load_dwordx4 v2, s[24:27], s75 offen offset:0  lds
    buffer_load_dwordx4 v3, s[24:27], s75 offen offset:1024  lds
    buffer_load_dwordx4 v4, s[24:27], s75 offen offset:2048  lds
    buffer_load_dwordx4 v5, s[24:27], s75 offen offset:3072  lds
    v_max3_f32 v12, v16, v17, v18
    v_mfma_f32_32x32x16_bf16 v[144:159], a[72:75], v[112:115], 0
    v_max3_f32 v13, v19, v20, v21
    v_max3_f32 v12, v12, v22, v23
    v_max3_f32 v13, v13, v24, v25
    v_max3_f32 v12, v12, v26, v27
    v_max3_f32 v13, v13, v28, v29
    v_max3_f32 v12, v12, v30, v31
    v_mfma_f32_32x32x16_bf16 v[160:175], a[80:83], v[112:115], 0
    v_max_f32 v12, v12, v13
    v_mov_b32 v13, v12
    s_nop 1
    v_permlane32_swap_b32 v12, v13
    v_max_f32 v12, v12, v13
    v_mul_f32 v12, s80, v12
    v_fma_f32 v16, v16, s80, -v12
    v_mfma_f32_32x32x16_bf16 v[176:191], a[88:91], v[112:115], 0
    v_fma_f32 v17, v17, s80, -v12
    v_fma_f32 v18, v18, s80, -v12
    s_waitcnt vmcnt(20)
    ds_read_b64_tr_b16 v[48:49], v6 offset:12288
    ds_read_b64_tr_b16 v[50:51], v6 offset:13312
    ds_read_b64_tr_b16 v[52:53], v7 offset:12288
    v_mfma_f32_32x32x16_bf16 v[128:143], a[68:71], v[116:119], v[128:143]
    ds_read_b64_tr_b16 v[54:55], v7 offset:13312
    ds_read_b64_tr_b16 v[56:57], v6 offset:14336
    ds_read_b64_tr_b16 v[58:59], v6 offset:15360
    ds_read_b64_tr_b16 v[60:61], v7 offset:14336
    ds_read_b64_tr_b16 v[62:63], v7 offset:15360
    v_fma_f32 v19, v19, s80, -v12
    v_mfma_f32_32x32x16_bf16 v[144:159], a[76:79], v[116:119], v[144:159]
    v_fma_f32 v20, v20, s80, -v12
    v_fma_f32 v21, v21, s80, -v12
    v_fma_f32 v22, v22, s80, -v12
    v_fma_f32 v23, v23, s80, -v12
    v_fma_f32 v24, v24, s80, -v12
    v_fma_f32 v25, v25, s80, -v12
    v_mfma_f32_32x32x16_bf16 v[160:175], a[84:87], v[116:119], v[160:175]
    v_fma_f32 v26, v26, s80, -v12
    v_fma_f32 v27, v27, s80, -v12
    v_fma_f32 v28, v28, s80, -v12
    v_fma_f32 v29, v29, s80, -v12
    v_fma_f32 v30, v30, s80, -v12
    v_fma_f32 v31, v31, s80, -v12
    v_mfma_f32_32x32x16_bf16 v[176:191], a[92:95], v[116:119], v[176:191]
    v_exp_f32 v16, v16
    v_exp_f32 v17, v17
    v_exp_f32 v18, v18
    v_exp_f32 v19, v19
    v_exp_f32 v20, v20
    v_exp_f32 v21, v21
    v_exp_f32 v22, v22
    v_exp_f32 v23, v23
    v_exp_f32 v24, v24
    v_exp_f32 v25, v25
    v_exp_f32 v26, v26
    v_exp_f32 v27, v27
    v_exp_f32 v28, v28
    v_exp_f32 v29, v29
    v_exp_f32 v30, v30
    v_exp_f32 v31, v31
    v_add_f32 v14, v16, v17
    v_add_f32 v13, v18, v19
    v_add_f32 v14, v14, v20
    v_add_f32 v13, v13, v21
    v_add_f32 v14, v14, v22
    v_add_f32 v13, v13, v23
    v_add_f32 v14, v14, v24
    v_add_f32 v13, v13, v25
    v_add_f32 v14, v14, v26
    v_add_f32 v13, v13, v27
    v_add_f32 v14, v14, v28
    v_add_f32 v13, v13, v29
    v_add_f32 v14, v14, v30
    v_add_f32 v13, v13, v31
    v_add_f32 v14, v14, v13
    v_mov_b32 v13, v14
    s_nop 1
    v_permlane32_swap_b32 v14, v13
    v_add_f32 v14, v14, v13
    v_rcp_f32 v14, v14
    s_nop 0
    v_mul_f32 v16, v16, v14
    v_mul_f32 v17, v17, v14
    v_mul_f32 v18, v18, v14
    v_mul_f32 v19, v19, v14
    v_mul_f32 v20, v20, v14
    v_mul_f32 v21, v21, v14
    v_mul_f32 v22, v22, v14
    v_mul_f32 v23, v23, v14
    v_mul_f32 v24, v24, v14
    v_mul_f32 v25, v25, v14
    v_mul_f32 v26, v26, v14
    v_mul_f32 v27, v27, v14
    v_mul_f32 v28, v28, v14
    v_mul_f32 v29, v29, v14
    v_mul_f32 v30, v30, v14
    v_mul_f32 v31, v31, v14
    v_cvt_pk_bf16_f32 v120, v16, v17
    v_cvt_pk_bf16_f32 v121, v18, v19
    v_cvt_pk_bf16_f32 v122, v20, v21
    v_cvt_pk_bf16_f32 v123, v22, v23
    v_cvt_pk_bf16_f32 v124, v24, v25
    v_cvt_pk_bf16_f32 v125, v26, v27
    v_cvt_pk_bf16_f32 v126, v28, v29
    v_cvt_pk_bf16_f32 v127, v30, v31
    s_barrier
    v_mfma_f32_32x32x16_bf16 v[192:207], a[96:99], v[120:123], 0
    v_cvt_pk_bf16_f32 v64, v128, v129
    v_cvt_pk_bf16_f32 v65, v130, v131
    v_cvt_pk_bf16_f32 v66, v132, v133
    v_cvt_pk_bf16_f32 v67, v134, v135
    ds_write_b128 v11, v[64:67] offset:0
    v_mfma_f32_32x32x16_bf16 v[208:223], a[104:107], v[120:123], 0
    v_cvt_pk_bf16_f32 v68, v136, v137
    v_cvt_pk_bf16_f32 v69, v138, v139
    v_cvt_pk_bf16_f32 v70, v140, v141
    v_cvt_pk_bf16_f32 v71, v142, v143
    ds_write_b128 v11, v[68:71] offset:1024
    v_mfma_f32_32x32x16_bf16 v[224:239], a[112:115], v[120:123], 0
    v_cvt_pk_bf16_f32 v72, v144, v145
    v_cvt_pk_bf16_f32 v73, v146, v147
    v_cvt_pk_bf16_f32 v74, v148, v149
    v_cvt_pk_bf16_f32 v75, v150, v151
    ds_write_b128 v11, v[72:75] offset:2048
    v_mfma_f32_32x32x16_bf16 v[240:255], a[120:123], v[120:123], 0
    v_cvt_pk_bf16_f32 v76, v152, v153
    v_cvt_pk_bf16_f32 v77, v154, v155
    v_cvt_pk_bf16_f32 v78, v156, v157
    v_cvt_pk_bf16_f32 v79, v158, v159
    v_mfma_f32_32x32x16_bf16 v[192:207], a[100:103], v[124:127], v[192:207]
    v_cvt_pk_bf16_f32 v80, v160, v161
    v_cvt_pk_bf16_f32 v81, v162, v163
    v_cvt_pk_bf16_f32 v82, v164, v165
    v_cvt_pk_bf16_f32 v83, v166, v167
    ds_write_b128 v11, v[76:79] offset:3072
    v_mfma_f32_32x32x16_bf16 v[208:223], a[108:111], v[124:127], v[208:223]
    v_cvt_pk_bf16_f32 v84, v168, v169
    v_cvt_pk_bf16_f32 v85, v170, v171
    v_cvt_pk_bf16_f32 v86, v172, v173
    v_cvt_pk_bf16_f32 v87, v174, v175
    ds_write_b128 v11, v[80:83] offset:4096
    v_mfma_f32_32x32x16_bf16 v[224:239], a[116:119], v[124:127], v[224:239]
    v_cvt_pk_bf16_f32 v88, v176, v177
    v_cvt_pk_bf16_f32 v89, v178, v179
    v_cvt_pk_bf16_f32 v90, v180, v181
    v_cvt_pk_bf16_f32 v91, v182, v183
    ds_write_b128 v11, v[84:87] offset:5120
    v_mfma_f32_32x32x16_bf16 v[240:255], a[124:127], v[124:127], v[240:255]
    v_cvt_pk_bf16_f32 v92, v184, v185
    v_cvt_pk_bf16_f32 v93, v186, v187
    v_cvt_pk_bf16_f32 v94, v188, v189
    v_cvt_pk_bf16_f32 v95, v190, v191
    v_mfma_f32_32x32x16_bf16 v[128:143], a[128:131], v[64:67], 0
    v_cvt_pk_bf16_f32 v96, v192, v193
    v_cvt_pk_bf16_f32 v97, v194, v195
    v_cvt_pk_bf16_f32 v98, v196, v197
    v_cvt_pk_bf16_f32 v99, v198, v199
    ds_write_b128 v11, v[88:91] offset:6144
    v_mfma_f32_32x32x16_bf16 v[160:175], a[132:135], v[64:67], 0
    v_cvt_pk_bf16_f32 v100, v200, v201
    v_cvt_pk_bf16_f32 v101, v202, v203
    v_cvt_pk_bf16_f32 v102, v204, v205
    v_cvt_pk_bf16_f32 v103, v206, v207
    s_waitcnt lgkmcnt(14)
    ds_write_b128 v11, v[92:95] offset:7168
    v_mfma_f32_32x32x16_bf16 v[128:143], a[136:139], v[68:71], v[128:143]
    v_cvt_pk_bf16_f32 v104, v208, v209
    v_cvt_pk_bf16_f32 v105, v210, v211
    v_cvt_pk_bf16_f32 v106, v212, v213
    v_cvt_pk_bf16_f32 v107, v214, v215
    v_mfma_f32_32x32x16_bf16 v[160:175], a[140:143], v[68:71], v[160:175]
    s_waitcnt lgkmcnt(8)
    s_add_u32 s75, s75, 40960
    s_add_u32 m0, s64, 12288
    s_nop 0
    buffer_load_dwordx4 v2, s[24:27], s75 offen offset:0  lds
    v_cvt_pk_bf16_f32 v108, v216, v217
    v_cvt_pk_bf16_f32 v109, v218, v219
    v_cvt_pk_bf16_f32 v110, v220, v221
    v_cvt_pk_bf16_f32 v111, v222, v223
    ds_write_b128 v11, v[96:99] offset:32768
    v_mfma_f32_32x32x16_bf16 v[144:159], a[128:131], v[96:99], 0
    buffer_load_dwordx4 v3, s[24:27], s75 offen offset:1024  lds
    v_cvt_pk_bf16_f32 v112, v224, v225
    v_cvt_pk_bf16_f32 v113, v226, v227
    v_cvt_pk_bf16_f32 v114, v228, v229
    v_cvt_pk_bf16_f32 v115, v230, v231
    ds_write_b128 v11, v[100:103] offset:33792
    v_mfma_f32_32x32x16_bf16 v[176:191], a[132:135], v[96:99], 0
    buffer_load_dwordx4 v4, s[24:27], s75 offen offset:2048  lds
    v_cvt_pk_bf16_f32 v116, v232, v233
    v_cvt_pk_bf16_f32 v117, v234, v235
    v_cvt_pk_bf16_f32 v118, v236, v237
    v_cvt_pk_bf16_f32 v119, v238, v239
    ds_write_b128 v11, v[104:107] offset:34816
    v_mfma_f32_32x32x16_bf16 v[144:159], a[136:139], v[100:103], v[144:159]
    buffer_load_dwordx4 v5, s[24:27], s75 offen offset:3072  lds
    v_cvt_pk_bf16_f32 v120, v240, v241
    v_cvt_pk_bf16_f32 v121, v242, v243
    v_cvt_pk_bf16_f32 v122, v244, v245
    v_cvt_pk_bf16_f32 v123, v246, v247
    v_mfma_f32_32x32x16_bf16 v[176:191], a[140:143], v[100:103], v[176:191]
    v_cvt_pk_bf16_f32 v124, v248, v249
    v_cvt_pk_bf16_f32 v125, v250, v251
    v_cvt_pk_bf16_f32 v126, v252, v253
    v_cvt_pk_bf16_f32 v127, v254, v255
    ds_write_b128 v11, v[108:111] offset:35840
    v_add_u32 v8, s40, v11
    v_mfma_f32_32x32x16_bf16 v[128:143], a[144:147], v[72:75], v[128:143]
    ds_write_b128 v11, v[112:115] offset:36864
    v_mfma_f32_32x32x16_bf16 v[160:175], a[148:151], v[72:75], v[160:175]
    s_waitcnt vmcnt(20)
    ds_read_b64_tr_b16 a[128:129], v6 offset:16384
    ds_read_b64_tr_b16 a[130:131], v6 offset:17408
    s_waitcnt lgkmcnt(14)
    ds_write_b128 v11, v[116:119] offset:37888
    v_mfma_f32_32x32x16_bf16 v[144:159], a[144:147], v[104:107], v[144:159]
    s_waitcnt lgkmcnt(14)
    ds_read_b64_tr_b16 a[132:133], v7 offset:16384
    s_waitcnt lgkmcnt(14)
    ds_read_b64_tr_b16 a[134:135], v7 offset:17408
    v_mfma_f32_32x32x16_bf16 v[176:191], a[148:151], v[104:107], v[176:191]
    s_waitcnt lgkmcnt(14)
    ds_read_b64_tr_b16 a[136:137], v6 offset:18432
    s_waitcnt lgkmcnt(14)
    ds_read_b64_tr_b16 a[138:139], v6 offset:19456
    s_waitcnt lgkmcnt(14)
    ds_write_b128 v11, v[120:123] offset:38912
    v_mfma_f32_32x32x16_bf16 v[128:143], a[152:155], v[76:79], v[128:143]
    s_waitcnt lgkmcnt(14)
    ds_read_b64_tr_b16 a[140:141], v7 offset:18432
    s_waitcnt lgkmcnt(14)
    ds_read_b64_tr_b16 a[142:143], v7 offset:19456
    s_waitcnt lgkmcnt(14)
    ds_write_b128 v11, v[124:127] offset:39936
    v_mfma_f32_32x32x16_bf16 v[160:175], a[156:159], v[76:79], v[160:175]
    v_mfma_f32_32x32x16_bf16 v[144:159], a[152:155], v[108:111], v[144:159]
    v_mfma_f32_32x32x16_bf16 v[176:191], a[156:159], v[108:111], v[176:191]
    s_waitcnt lgkmcnt(1)
    s_waitcnt lgkmcnt(0)
    s_barrier
    v_mfma_f32_32x32x16_bf16 v[128:143], a[160:163], v[80:83], v[128:143]
    s_add_u32 s75, s71, s72
    s_add_u32 m0, s64, 16384
    s_nop 0
    buffer_load_dwordx4 v2, s[24:27], s75 offen offset:0  lds
    v_mfma_f32_32x32x16_bf16 v[160:175], a[164:167], v[80:83], v[160:175]
    buffer_load_dwordx4 v3, s[24:27], s75 offen offset:1024  lds
    s_waitcnt vmcnt(18)
    ds_read_b64_tr_b16 a[144:145], v6 offset:20480
    ds_read_b64_tr_b16 a[146:147], v6 offset:21504
    v_mfma_f32_32x32x16_bf16 v[144:159], a[160:163], v[112:115], v[144:159]
    buffer_load_dwordx4 v4, s[24:27], s75 offen offset:2048  lds
    ds_read_b64_tr_b16 a[148:149], v7 offset:20480
    ds_read_b64_tr_b16 a[150:151], v7 offset:21504
    v_mfma_f32_32x32x16_bf16 v[176:191], a[164:167], v[112:115], v[176:191]
    buffer_load_dwordx4 v5, s[24:27], s75 offen offset:3072  lds
    ds_read_b64_tr_b16 a[152:153], v6 offset:22528
    ds_read_b64_tr_b16 a[154:155], v6 offset:23552
    v_mfma_f32_32x32x16_bf16 v[128:143], a[168:171], v[84:87], v[128:143]
    ds_read_b64_tr_b16 a[156:157], v7 offset:22528
    ds_read_b64_tr_b16 a[158:159], v7 offset:23552
    ds_read_b128 a[0:3], v8 offset:0
    ds_read_b128 a[32:35], v8 offset:32768
    v_mfma_f32_32x32x16_bf16 v[160:175], a[172:175], v[84:87], v[160:175]
    ds_read_b128 a[4:7], v8 offset:1024
    ds_read_b128 a[36:39], v8 offset:33792
    v_mfma_f32_32x32x16_bf16 v[144:159], a[168:171], v[116:119], v[144:159]
    ds_read_b128 a[8:11], v8 offset:2048
    ds_read_b128 a[40:43], v8 offset:34816
    v_mfma_f32_32x32x16_bf16 v[176:191], a[172:175], v[116:119], v[176:191]
    ds_read_b128 a[12:15], v8 offset:3072
    s_waitcnt lgkmcnt(14)
    ds_read_b128 a[44:47], v8 offset:35840
    s_waitcnt lgkmcnt(8)
    v_mfma_f32_32x32x16_bf16 v[128:143], a[176:179], v[88:91], v[128:143]
    s_add_u32 s75, s75, 40960
    s_add_u32 m0, s64, 20480
    s_nop 0
    buffer_load_dwordx4 v2, s[24:27], s75 offen offset:0  lds
    v_mfma_f32_32x32x16_bf16 v[160:175], a[180:183], v[88:91], v[160:175]
    buffer_load_dwordx4 v3, s[24:27], s75 offen offset:1024  lds
    s_waitcnt vmcnt(18)
    ds_read_b64_tr_b16 v[192:193], v6 offset:0
    ds_read_b64_tr_b16 v[194:195], v6 offset:1024
    v_mfma_f32_32x32x16_bf16 v[144:159], a[176:179], v[120:123], v[144:159]
    buffer_load_dwordx4 v4, s[24:27], s75 offen offset:2048  lds
    ds_read_b64_tr_b16 v[196:197], v7 offset:0
    ds_read_b64_tr_b16 v[198:199], v7 offset:1024
    v_mfma_f32_32x32x16_bf16 v[176:191], a[180:183], v[120:123], v[176:191]
    buffer_load_dwordx4 v5, s[24:27], s75 offen offset:3072  lds
    ds_read_b64_tr_b16 v[200:201], v6 offset:2048
    ds_read_b64_tr_b16 v[202:203], v6 offset:3072
    v_mfma_f32_32x32x16_bf16 v[128:143], a[184:187], v[92:95], v[128:143]
    ds_read_b64_tr_b16 v[204:205], v7 offset:2048
    s_waitcnt lgkmcnt(14)
    ds_read_b64_tr_b16 v[206:207], v7 offset:3072
    s_waitcnt lgkmcnt(14)
    ds_read_b128 a[16:19], v8 offset:4096
    s_waitcnt lgkmcnt(14)
    ds_read_b128 a[48:51], v8 offset:36864
    v_mfma_f32_32x32x16_bf16 v[160:175], a[188:191], v[92:95], v[160:175]
    s_waitcnt lgkmcnt(14)
    ds_read_b128 a[20:23], v8 offset:5120
    s_waitcnt lgkmcnt(14)
    ds_read_b128 a[52:55], v8 offset:37888
    v_mfma_f32_32x32x16_bf16 v[144:159], a[184:187], v[124:127], v[144:159]
    s_waitcnt lgkmcnt(14)
    ds_read_b128 a[24:27], v8 offset:6144
    s_waitcnt lgkmcnt(14)
    ds_read_b128 a[56:59], v8 offset:38912
    v_mfma_f32_32x32x16_bf16 v[176:191], a[188:191], v[124:127], v[176:191]
    v_add_u32 v9, s41, v11
    s_waitcnt lgkmcnt(14)
    ds_read_b128 a[28:31], v8 offset:7168
    s_waitcnt lgkmcnt(14)
    ds_read_b128 a[60:63], v8 offset:39936
    s_waitcnt lgkmcnt(8)
    v_mfma_f32_32x32x16_bf16 v[128:143], v[32:35], a[0:3], v[128:143]
    s_add_u32 s75, s75, 40960
    s_add_u32 m0, s64, 0
    s_nop 0
    buffer_load_dwordx4 v2, s[24:27], s75 offen offset:0  lds
    v_mfma_f32_32x32x16_bf16 v[160:175], v[36:39], a[0:3], v[160:175]
    buffer_load_dwordx4 v3, s[24:27], s75 offen offset:1024  lds
    s_waitcnt vmcnt(18)
    ds_read_b64_tr_b16 v[208:209], v6 offset:4096
    ds_read_b64_tr_b16 v[210:211], v6 offset:5120
    v_mfma_f32_32x32x16_bf16 v[144:159], v[32:35], a[32:35], v[144:159]
    buffer_load_dwordx4 v4, s[24:27], s75 offen offset:2048  lds
    ds_read_b64_tr_b16 v[212:213], v7 offset:4096
    ds_read_b64_tr_b16 v[214:215], v7 offset:5120
    v_mfma_f32_32x32x16_bf16 v[176:191], v[36:39], a[32:35], v[176:191]
    buffer_load_dwordx4 v5, s[24:27], s75 offen offset:3072  lds
    ds_read_b64_tr_b16 v[216:217], v6 offset:6144
    ds_read_b64_tr_b16 v[218:219], v6 offset:7168
    v_mfma_f32_32x32x16_bf16 v[128:143], v[40:43], a[4:7], v[128:143]
    ds_read_b64_tr_b16 v[220:221], v7 offset:6144
    s_waitcnt lgkmcnt(14)
    ds_read_b64_tr_b16 v[222:223], v7 offset:7168
    v_mfma_f32_32x32x16_bf16 v[160:175], v[44:47], a[4:7], v[160:175]
    s_waitcnt lgkmcnt(14)
    ds_read_b128 a[64:67], v9 offset:0
    s_waitcnt lgkmcnt(14)
    ds_read_b128 a[96:99], v9 offset:32768
    v_mfma_f32_32x32x16_bf16 v[144:159], v[40:43], a[36:39], v[144:159]
    s_waitcnt lgkmcnt(14)
    ds_read_b128 a[68:71], v9 offset:1024
    s_waitcnt lgkmcnt(14)
    ds_read_b128 a[100:103], v9 offset:33792
    v_mfma_f32_32x32x16_bf16 v[176:191], v[44:47], a[36:39], v[176:191]
    s_waitcnt lgkmcnt(4)
    v_mfma_f32_32x32x16_bf16 v[128:143], v[48:51], a[8:11], v[128:143]
    s_add_u32 s75, s75, 40960
    s_add_u32 m0, s64, 4096
    s_nop 0
    buffer_load_dwordx4 v2, s[24:27], s75 offen offset:0  lds
    v_mfma_f32_32x32x16_bf16 v[160:175], v[52:55], a[8:11], v[160:175]
    buffer_load_dwordx4 v3, s[24:27], s75 offen offset:1024  lds
    s_waitcnt vmcnt(18)
    ds_read_b64_tr_b16 v[224:225], v6 offset:8192
    ds_read_b64_tr_b16 v[226:227], v6 offset:9216
    v_mfma_f32_32x32x16_bf16 v[144:159], v[48:51], a[40:43], v[144:159]
    buffer_load_dwordx4 v4, s[24:27], s75 offen offset:2048  lds
    ds_read_b64_tr_b16 v[228:229], v7 offset:8192
    ds_read_b64_tr_b16 v[230:231], v7 offset:9216
    v_mfma_f32_32x32x16_bf16 v[176:191], v[52:55], a[40:43], v[176:191]
    buffer_load_dwordx4 v5, s[24:27], s75 offen offset:3072  lds
    ds_read_b64_tr_b16 v[232:233], v6 offset:10240
    ds_read_b64_tr_b16 v[234:235], v6 offset:11264
    v_mfma_f32_32x32x16_bf16 v[128:143], v[56:59], a[12:15], v[128:143]
    ds_read_b64_tr_b16 v[236:237], v7 offset:10240
    ds_read_b64_tr_b16 v[238:239], v7 offset:11264
    v_mfma_f32_32x32x16_bf16 v[160:175], v[60:63], a[12:15], v[160:175]
    ds_read_b128 a[72:75], v9 offset:2048
    ds_read_b128 a[104:107], v9 offset:34816
    v_mfma_f32_32x32x16_bf16 v[144:159], v[56:59], a[44:47], v[144:159]
    ds_read_b128 a[76:79], v9 offset:3072
    s_waitcnt lgkmcnt(14)
    ds_read_b128 a[108:111], v9 offset:35840
    v_mfma_f32_32x32x16_bf16 v[176:191], v[60:63], a[44:47], v[176:191]
    s_waitcnt lgkmcnt(4)
    v_mfma_f32_32x32x16_bf16 v[128:143], a[128:131], a[16:19], v[128:143]
    s_add_u32 s75, s68, s73
    s_add_u32 m0, s64, 8192
    s_nop 0
    buffer_load_dwordx4 v2, s[24:27], s75 offen offset:0  lds
    v_mfma_f32_32x32x16_bf16 v[160:175], a[132:135], a[16:19], v[160:175]
    buffer_load_dwordx4 v3, s[24:27], s75 offen offset:1024  lds
    s_waitcnt vmcnt(18)
    ds_read_b64_tr_b16 v[240:241], v6 offset:12288
    ds_read_b64_tr_b16 v[242:243], v6 offset:13312
    v_mfma_f32_32x32x16_bf16 v[144:159], a[128:131], a[48:51], v[144:159]
    buffer_load_dwordx4 v4, s[24:27], s75 offen offset:2048  lds
    ds_read_b64_tr_b16 v[244:245], v7 offset:12288
    ds_read_b64_tr_b16 v[246:247], v7 offset:13312
    v_mfma_f32_32x32x16_bf16 v[176:191], a[132:135], a[48:51], v[176:191]
    buffer_load_dwordx4 v5, s[24:27], s75 offen offset:3072  lds
    ds_read_b64_tr_b16 v[248:249], v6 offset:14336
    ds_read_b64_tr_b16 v[250:251], v6 offset:15360
    v_mfma_f32_32x32x16_bf16 v[128:143], a[136:139], a[20:23], v[128:143]
    ds_read_b64_tr_b16 v[252:253], v7 offset:14336
    ds_read_b64_tr_b16 v[254:255], v7 offset:15360
    v_mfma_f32_32x32x16_bf16 v[160:175], a[140:143], a[20:23], v[160:175]
    ds_read_b128 a[80:83], v9 offset:4096
    ds_read_b128 a[112:115], v9 offset:36864
    v_mfma_f32_32x32x16_bf16 v[144:159], a[136:139], a[52:55], v[144:159]
    ds_read_b128 a[84:87], v9 offset:5120
    s_waitcnt lgkmcnt(14)
    ds_read_b128 a[116:119], v9 offset:37888
    v_mfma_f32_32x32x16_bf16 v[176:191], a[140:143], a[52:55], v[176:191]
    s_waitcnt lgkmcnt(4)
    v_mfma_f32_32x32x16_bf16 v[128:143], a[144:147], a[24:27], v[128:143]
    s_add_u32 s75, s75, 40960
    s_add_u32 m0, s64, 12288
    s_nop 0
    buffer_load_dwordx4 v2, s[24:27], s75 offen offset:0  lds
    v_mfma_f32_32x32x16_bf16 v[160:175], a[148:151], a[24:27], v[160:175]
    buffer_load_dwordx4 v3, s[24:27], s75 offen offset:1024  lds
    s_waitcnt vmcnt(18)
    ds_read_b64_tr_b16 v[32:33], v6 offset:16384
    ds_read_b64_tr_b16 v[34:35], v6 offset:17408
    v_mfma_f32_32x32x16_bf16 v[144:159], a[144:147], a[56:59], v[144:159]
    buffer_load_dwordx4 v4, s[24:27], s75 offen offset:2048  lds
    ds_read_b64_tr_b16 v[36:37], v7 offset:16384
    ds_read_b64_tr_b16 v[38:39], v7 offset:17408
    v_mfma_f32_32x32x16_bf16 v[176:191], a[148:151], a[56:59], v[176:191]
    buffer_load_dwordx4 v5, s[24:27], s75 offen offset:3072  lds
    ds_read_b64_tr_b16 v[40:41], v6 offset:18432
    ds_read_b64_tr_b16 v[42:43], v6 offset:19456
    v_mfma_f32_32x32x16_bf16 v[128:143], a[152:155], a[28:31], v[128:143]
    ds_read_b64_tr_b16 v[44:45], v7 offset:18432
    ds_read_b64_tr_b16 v[46:47], v7 offset:19456
    v_mfma_f32_32x32x16_bf16 v[160:175], a[156:159], a[28:31], v[160:175]
    ds_read_b128 a[88:91], v9 offset:6144
    ds_read_b128 a[120:123], v9 offset:38912
    v_mfma_f32_32x32x16_bf16 v[144:159], a[152:155], a[60:63], v[144:159]
    ds_read_b128 a[92:95], v9 offset:7168
    s_waitcnt lgkmcnt(14)
    ds_read_b128 a[124:127], v9 offset:39936
    v_mfma_f32_32x32x16_bf16 v[176:191], a[156:159], a[60:63], v[176:191]
    v_add_u32 v10, s42, v11
    s_waitcnt lgkmcnt(0)
    v_mfma_f32_32x32x16_bf16 v[128:143], v[192:195], a[64:67], v[128:143]
    s_add_u32 s75, s75, 40960
    s_add_u32 m0, s64, 16384
    s_nop 0
    buffer_load_dwordx4 v2, s[24:27], s75 offen offset:0  lds
    v_mfma_f32_32x32x16_bf16 v[160:175], v[196:199], a[64:67], v[160:175]
    buffer_load_dwordx4 v3, s[24:27], s75 offen offset:1024  lds
    s_waitcnt vmcnt(18)
    ds_read_b64_tr_b16 v[48:49], v6 offset:20480
    ds_read_b64_tr_b16 v[50:51], v6 offset:21504
    v_mfma_f32_32x32x16_bf16 v[144:159], v[192:195], a[96:99], v[144:159]
    buffer_load_dwordx4 v4, s[24:27], s75 offen offset:2048  lds
    ds_read_b64_tr_b16 v[52:53], v7 offset:20480
    ds_read_b64_tr_b16 v[54:55], v7 offset:21504
    v_mfma_f32_32x32x16_bf16 v[176:191], v[196:199], a[96:99], v[176:191]
    buffer_load_dwordx4 v5, s[24:27], s75 offen offset:3072  lds
    ds_read_b64_tr_b16 v[56:57], v6 offset:22528
    ds_read_b64_tr_b16 v[58:59], v6 offset:23552
    v_mfma_f32_32x32x16_bf16 v[128:143], v[200:203], a[68:71], v[128:143]
    ds_read_b64_tr_b16 v[60:61], v7 offset:22528
    ds_read_b64_tr_b16 v[62:63], v7 offset:23552
    v_mfma_f32_32x32x16_bf16 v[160:175], v[204:207], a[68:71], v[160:175]
    ds_read_b128 a[128:131], v10 offset:0
    ds_read_b128 a[160:163], v10 offset:32768
    v_mfma_f32_32x32x16_bf16 v[144:159], v[200:203], a[100:103], v[144:159]
    ds_read_b128 a[132:135], v10 offset:1024
    ds_read_b128 a[164:167], v10 offset:33792
    v_mfma_f32_32x32x16_bf16 v[176:191], v[204:207], a[100:103], v[176:191]
    s_waitcnt lgkmcnt(4)
    v_mfma_f32_32x32x16_bf16 v[128:143], v[208:211], a[72:75], v[128:143]
    s_add_u32 s75, s75, 40960
    s_add_u32 m0, s64, 20480
    s_nop 0
    buffer_load_dwordx4 v2, s[24:27], s75 offen offset:0  lds
    v_mfma_f32_32x32x16_bf16 v[160:175], v[212:215], a[72:75], v[160:175]
    buffer_load_dwordx4 v3, s[24:27], s75 offen offset:1024  lds
    s_waitcnt vmcnt(18)
    ds_read_b64_tr_b16 v[192:193], v6 offset:0
    ds_read_b64_tr_b16 v[194:195], v6 offset:1024
    v_mfma_f32_32x32x16_bf16 v[144:159], v[208:211], a[104:107], v[144:159]
    buffer_load_dwordx4 v4, s[24:27], s75 offen offset:2048  lds
    ds_read_b64_tr_b16 v[196:197], v7 offset:0
    ds_read_b64_tr_b16 v[198:199], v7 offset:1024
    v_mfma_f32_32x32x16_bf16 v[176:191], v[212:215], a[104:107], v[176:191]
    buffer_load_dwordx4 v5, s[24:27], s75 offen offset:3072  lds
    ds_read_b64_tr_b16 v[200:201], v6 offset:2048
    ds_read_b64_tr_b16 v[202:203], v6 offset:3072
    v_mfma_f32_32x32x16_bf16 v[128:143], v[216:219], a[76:79], v[128:143]
    ds_read_b64_tr_b16 v[204:205], v7 offset:2048
    ds_read_b64_tr_b16 v[206:207], v7 offset:3072
    v_mfma_f32_32x32x16_bf16 v[160:175], v[220:223], a[76:79], v[160:175]
    ds_read_b128 a[136:139], v10 offset:2048
    ds_read_b128 a[168:171], v10 offset:34816
    v_mfma_f32_32x32x16_bf16 v[144:159], v[216:219], a[108:111], v[144:159]
    ds_read_b128 a[140:143], v10 offset:3072
    s_waitcnt lgkmcnt(14)
    ds_read_b128 a[172:175], v10 offset:35840
    v_mfma_f32_32x32x16_bf16 v[176:191], v[220:223], a[108:111], v[176:191]
    s_waitcnt lgkmcnt(4)
    v_mfma_f32_32x32x16_bf16 v[128:143], v[224:227], a[80:83], v[128:143]
    s_add_u32 s75, s69, s73
    s_add_u32 m0, s64, 0
    s_nop 0
    buffer_load_dwordx4 v2, s[24:27], s75 offen offset:0  lds
    v_mfma_f32_32x32x16_bf16 v[160:175], v[228:231], a[80:83], v[160:175]
    buffer_load_dwordx4 v3, s[24:27], s75 offen offset:1024  lds
    v_mfma_f32_32x32x16_bf16 v[144:159], v[224:227], a[112:115], v[144:159]
    buffer_load_dwordx4 v4, s[24:27], s75 offen offset:2048  lds
    v_mfma_f32_32x32x16_bf16 v[176:191], v[228:231], a[112:115], v[176:191]
    buffer_load_dwordx4 v5, s[24:27], s75 offen offset:3072  lds
    v_mfma_f32_32x32x16_bf16 v[128:143], v[232:235], a[84:87], v[128:143]
    v_mfma_f32_32x32x16_bf16 v[160:175], v[236:239], a[84:87], v[160:175]
    ds_read_b128 a[144:147], v10 offset:4096
    ds_read_b128 a[176:179], v10 offset:36864
    v_mfma_f32_32x32x16_bf16 v[144:159], v[232:235], a[116:119], v[144:159]
    ds_read_b128 a[148:151], v10 offset:5120
    ds_read_b128 a[180:183], v10 offset:37888
    v_mfma_f32_32x32x16_bf16 v[176:191], v[236:239], a[116:119], v[176:191]
    v_mfma_f32_32x32x16_bf16 v[128:143], v[240:243], a[88:91], v[128:143]
    v_mfma_f32_32x32x16_bf16 v[160:175], v[244:247], a[88:91], v[160:175]
    s_waitcnt vmcnt(20)
    ds_read_b64_tr_b16 v[208:209], v6 offset:4096
    ds_read_b64_tr_b16 v[210:211], v6 offset:5120
    v_mfma_f32_32x32x16_bf16 v[144:159], v[240:243], a[120:123], v[144:159]
    ds_read_b64_tr_b16 v[212:213], v7 offset:4096
    ds_read_b64_tr_b16 v[214:215], v7 offset:5120
    v_mfma_f32_32x32x16_bf16 v[176:191], v[244:247], a[120:123], v[176:191]
    ds_read_b64_tr_b16 v[216:217], v6 offset:6144
    ds_read_b64_tr_b16 v[218:219], v6 offset:7168
    v_mfma_f32_32x32x16_bf16 v[128:143], v[248:251], a[92:95], v[128:143]
    ds_read_b64_tr_b16 v[220:221], v7 offset:6144
    s_waitcnt lgkmcnt(14)
    ds_read_b64_tr_b16 v[222:223], v7 offset:7168
    v_mfma_f32_32x32x16_bf16 v[160:175], v[252:255], a[92:95], v[160:175]
    s_waitcnt lgkmcnt(14)
    ds_read_b128 a[152:155], v10 offset:6144
    s_waitcnt lgkmcnt(14)
    ds_read_b128 a[184:187], v10 offset:38912
    v_mfma_f32_32x32x16_bf16 v[144:159], v[248:251], a[124:127], v[144:159]
    s_waitcnt lgkmcnt(14)
    ds_read_b128 a[156:159], v10 offset:7168
    s_waitcnt lgkmcnt(14)
    ds_read_b128 a[188:191], v10 offset:39936
    v_mfma_f32_32x32x16_bf16 v[176:191], v[252:255], a[124:127], v[176:191]
    s_waitcnt lgkmcnt(0)
    v_mfma_f32_32x32x16_bf16 v[128:143], v[32:35], a[128:131], v[128:143]
    s_add_u32 s75, s75, 40960
    s_add_u32 m0, s64, 4096
    s_nop 0
    buffer_load_dwordx4 v2, s[24:27], s75 offen offset:0  lds
    v_mfma_f32_32x32x16_bf16 v[160:175], v[36:39], a[128:131], v[160:175]
    buffer_load_dwordx4 v3, s[24:27], s75 offen offset:1024  lds
    s_waitcnt vmcnt(18)
    ds_read_b64_tr_b16 a[192:193], v6 offset:8192
    ds_read_b64_tr_b16 a[194:195], v6 offset:9216
    v_mfma_f32_32x32x16_bf16 v[144:159], v[32:35], a[160:163], v[144:159]
    buffer_load_dwordx4 v4, s[24:27], s75 offen offset:2048  lds
    ds_read_b64_tr_b16 a[196:197], v7 offset:8192
    ds_read_b64_tr_b16 a[198:199], v7 offset:9216
    v_mfma_f32_32x32x16_bf16 v[176:191], v[36:39], a[160:163], v[176:191]
    buffer_load_dwordx4 v5, s[24:27], s75 offen offset:3072  lds
    ds_read_b64_tr_b16 a[200:201], v6 offset:10240
    ds_read_b64_tr_b16 a[202:203], v6 offset:11264
    v_mfma_f32_32x32x16_bf16 v[128:143], v[40:43], a[132:135], v[128:143]
    ds_read_b64_tr_b16 a[204:205], v7 offset:10240
    ds_read_b64_tr_b16 a[206:207], v7 offset:11264
    s_lshr_b32 s40, s34, 2
    s_and_b32 s41, s34, 3
    s_lshl_b32 s40, s40, 11
    s_lshl_b32 s41, s41, 7
    s_add_u32 s40, s40, s41
    v_mfma_f32_32x32x16_bf16 v[160:175], v[44:47], a[132:135], v[160:175]
    s_mul_i32 s45, s44, 655360
    s_add_u32 s45, s45, s40
    s_mul_i32 s42, s35, 163840
    s_mul_i32 s43, s33, 1280
    s_add_u32 s42, s42, s43
    v_mfma_f32_32x32x16_bf16 v[144:159], v[40:43], a[164:167], v[144:159]
    s_mul_i32 s43, s34, 20480
    s_add_u32 s42, s42, s43
    s_mov_b32 s12, s36
    s_mov_b32 s13, s37
    s_mov_b32 s14, 2621440
    v_mfma_f32_32x32x16_bf16 v[176:191], v[44:47], a[164:167], v[176:191]
    s_mov_b32 s16, s38
    s_mov_b32 s17, s39
    s_mov_b32 s18, 256
    s_lshl_b32 s53, 0x010101, s34
    s_mov_b32 s54, 0
    s_waitcnt lgkmcnt(0)
    v_mfma_f32_32x32x16_bf16 v[128:143], v[48:51], a[136:139], v[128:143]
    s_add_u32 s75, s75, 40960
    s_add_u32 m0, s64, 8192
    s_nop 0
    buffer_load_dwordx4 v2, s[24:27], s75 offen offset:0  lds
    v_mfma_f32_32x32x16_bf16 v[160:175], v[52:55], a[136:139], v[160:175]
    buffer_load_dwordx4 v3, s[24:27], s75 offen offset:1024  lds
    s_waitcnt vmcnt(18)
    ds_read_b64_tr_b16 v[32:33], v6 offset:12288
    ds_read_b64_tr_b16 v[34:35], v6 offset:13312
    v_mfma_f32_32x32x16_bf16 v[144:159], v[48:51], a[168:171], v[144:159]
    buffer_load_dwordx4 v4, s[24:27], s75 offen offset:2048  lds
    ds_read_b64_tr_b16 v[36:37], v7 offset:12288
    ds_read_b64_tr_b16 v[38:39], v7 offset:13312
    v_mfma_f32_32x32x16_bf16 v[176:191], v[52:55], a[168:171], v[176:191]
    buffer_load_dwordx4 v5, s[24:27], s75 offen offset:3072  lds
    ds_read_b64_tr_b16 v[40:41], v6 offset:14336
    ds_read_b64_tr_b16 v[42:43], v6 offset:15360
    v_mfma_f32_32x32x16_bf16 v[128:143], v[56:59], a[140:143], v[128:143]
    ds_read_b64_tr_b16 v[44:45], v7 offset:14336
    ds_read_b64_tr_b16 v[46:47], v7 offset:15360
    s_mov_b32 s55, 1024
    s_and_b32 s46, s32, 1
    s_lshl_b32 s47, s46, 7
    s_sub_u32 s47, s50, s47
    s_lshl_b32 s43, s44, 3
    v_mfma_f32_32x32x16_bf16 v[160:175], v[60:63], a[140:143], v[160:175]
    v_mov_b32 v16, 268435456
    v_lshlrev_b32 v14, 9, v0
    v_lshrrev_b32 v17, 2, v0
    v_cmp_eq_u32 vcc, s46, v17
    s_nop 1
    v_cndmask_b32 v15, v16, v14, vcc
    v_mfma_f32_32x32x16_bf16 v[144:159], v[56:59], a[172:175], v[144:159]
    v_cmp_gt_u32 vcc, 8, v0
    s_nop 1
    v_cndmask_b32 v14, v16, v14, vcc
    v_lshlrev_b32 v18, 2, v0
    v_add_u32 v18, 0, v18
    v_cmp_gt_u32 vcc, 1, v0
    v_mfma_f32_32x32x16_bf16 v[176:191], v[60:63], a[172:175], v[176:191]
    s_nop 0
    v_cndmask_b32 v18, v16, v18, vcc
    v_lshrrev_b32 v20, 4, v0
    v_lshrrev_b32 v21, 1, v20
    v_and_b32 v20, 1, v20
    v_bfe_u32 v22, v0, 3, 1
    s_waitcnt lgkmcnt(0)
    v_mfma_f32_32x32x16_bf16 v[128:143], v[192:195], a[144:147], v[128:143]
    s_add_u32 s75, s75, 40960
    s_add_u32 m0, s64, 12288
    s_nop 0
    buffer_load_dwordx4 v2, s[24:27], s75 offen offset:0  lds
    v_mfma_f32_32x32x16_bf16 v[160:175], v[196:199], a[144:147], v[160:175]
    buffer_load_dwordx4 v3, s[24:27], s75 offen offset:1024  lds
    s_waitcnt vmcnt(18)
    ds_read_b64_tr_b16 v[48:49], v6 offset:16384
    ds_read_b64_tr_b16 v[50:51], v6 offset:17408
    v_mfma_f32_32x32x16_bf16 v[144:159], v[192:195], a[176:179], v[144:159]
    buffer_load_dwordx4 v4, s[24:27], s75 offen offset:2048  lds
    ds_read_b64_tr_b16 v[52:53], v7 offset:16384
    ds_read_b64_tr_b16 v[54:55], v7 offset:17408
    v_mfma_f32_32x32x16_bf16 v[176:191], v[196:199], a[176:179], v[176:191]
    buffer_load_dwordx4 v5, s[24:27], s75 offen offset:3072  lds
    ds_read_b64_tr_b16 v[56:57], v6 offset:18432
    ds_read_b64_tr_b16 v[58:59], v6 offset:19456
    v_mfma_f32_32x32x16_bf16 v[128:143], v[200:203], a[148:151], v[128:143]
    ds_read_b64_tr_b16 v[60:61], v7 offset:18432
    ds_read_b64_tr_b16 v[62:63], v7 offset:19456
    v_and_b32 v23, 7, v0
    v_lshlrev_b32 v19, 12, v21
    v_lshl_add_u32 v19, v20, 10, v19
    v_lshl_add_u32 v19, v22, 9, v19
    v_lshl_add_u32 v19, v23, 4, v19
    v_mfma_f32_32x32x16_bf16 v[160:175], v[204:207], a[148:151], v[160:175]
    v_mul_u32_u24 v13, 2560, v23
    v_lshl_add_u32 v13, v21, 6, v13
    v_lshl_add_u32 v13, v20, 5, v13
    v_lshl_add_u32 v13, v22, 4, v13
    v_mov_b32 v17, 1
    v_mfma_f32_32x32x16_bf16 v[144:159], v[200:203], a[180:183], v[144:159]
    v_lshlrev_b32 v17, s34, v17
    v_mov_b32 v16, 0
    v_and_b32 v20, 31, v0
    v_lshrrev_b32 v21, 5, v0
    v_lshlrev_b32 v21, 3, v21
    v_mfma_f32_32x32x16_bf16 v[176:191], v[204:207], a[180:183], v[176:191]
    v_sub_u32 v20, v20, v21
    v_and_b32 v21, 1, v20
    v_lshlrev_b32 v21, 4, v21
    v_mov_b32 v22, 0x3f80
    v_lshlrev_b32 v21, v21, v22
    s_waitcnt lgkmcnt(0)
    v_mfma_f32_32x32x16_bf16 v[128:143], v[208:211], a[152:155], v[128:143]
    s_add_u32 s75, s70, s73
    s_add_u32 m0, s64, 16384
    s_nop 0
    buffer_load_dwordx4 v2, s[24:27], s75 offen offset:0  lds
    v_mfma_f32_32x32x16_bf16 v[160:175], v[212:215], a[152:155], v[160:175]
    buffer_load_dwordx4 v3, s[24:27], s75 offen offset:1024  lds
    s_waitcnt vmcnt(18)
    ds_read_b64_tr_b16 a[208:209], v6 offset:20480
    ds_read_b64_tr_b16 a[210:211], v6 offset:21504
    v_mfma_f32_32x32x16_bf16 v[144:159], v[208:211], a[184:187], v[144:159]
    buffer_load_dwordx4 v4, s[24:27], s75 offen offset:2048  lds
    ds_read_b64_tr_b16 a[212:213], v7 offset:20480
    ds_read_b64_tr_b16 a[214:215], v7 offset:21504
    v_mfma_f32_32x32x16_bf16 v[176:191], v[212:215], a[184:187], v[176:191]
    buffer_load_dwordx4 v5, s[24:27], s75 offen offset:3072  lds
    ds_read_b64_tr_b16 a[216:217], v6 offset:22528
    ds_read_b64_tr_b16 a[218:219], v6 offset:23552
    v_mfma_f32_32x32x16_bf16 v[128:143], v[216:219], a[156:159], v[128:143]
    ds_read_b64_tr_b16 a[220:221], v7 offset:22528
    ds_read_b64_tr_b16 a[222:223], v7 offset:23552
    v_ashrrev_i32 v20, 1, v20
    v_cmp_eq_u32 vcc, 0, v20
    s_nop 1
    v_cndmask_b32 v24, 0, v21, vcc
    v_cmp_eq_u32 vcc, 1, v20
    s_nop 1
    v_cndmask_b32 v25, 0, v21, vcc
    v_mfma_f32_32x32x16_bf16 v[160:175], v[220:223], a[156:159], v[160:175]
    v_cmp_eq_u32 vcc, 2, v20
    s_nop 1
    v_cndmask_b32 v26, 0, v21, vcc
    v_cmp_eq_u32 vcc, 3, v20
    s_nop 1
    v_cndmask_b32 v27, 0, v21, vcc
    v_lshlrev_b32 v12, 4, v0
    v_mfma_f32_32x32x16_bf16 v[144:159], v[216:219], a[188:191], v[144:159]
    v_mfma_f32_32x32x16_bf16 v[176:191], v[220:223], a[188:191], v[176:191]
    s_waitcnt lgkmcnt(0)
    v_mfma_f32_32x32x16_bf16 v[192:207], a[192:195], v[64:67], 0
    s_add_u32 s75, s75, 40960
    s_add_u32 m0, s64, 20480
    s_nop 0
    buffer_load_dwordx4 v2, s[24:27], s75 offen offset:0  lds
    v_mfma_f32_32x32x16_bf16 v[224:239], a[196:199], v[64:67], 0
    buffer_load_dwordx4 v3, s[24:27], s75 offen offset:1024  lds
    s_waitcnt vmcnt(18)
    ds_read_b64_tr_b16 a[224:225], v6 offset:0
    ds_read_b64_tr_b16 a[226:227], v6 offset:1024
    v_mfma_f32_32x32x16_bf16 v[208:223], a[192:195], v[96:99], 0
    buffer_load_dwordx4 v4, s[24:27], s75 offen offset:2048  lds
    ds_read_b64_tr_b16 a[228:229], v7 offset:0
    ds_read_b64_tr_b16 a[230:231], v7 offset:1024
    v_mfma_f32_32x32x16_bf16 v[240:255], a[196:199], v[96:99], 0
    buffer_load_dwordx4 v5, s[24:27], s75 offen offset:3072  lds
    ds_read_b64_tr_b16 a[232:233], v6 offset:2048
    ds_read_b64_tr_b16 a[234:235], v6 offset:3072
    v_mfma_f32_32x32x16_bf16 v[192:207], a[200:203], v[68:71], v[192:207]
    ds_read_b64_tr_b16 a[236:237], v7 offset:2048
    ds_read_b64_tr_b16 a[238:239], v7 offset:3072
    v_cvt_pk_bf16_f32 v128, v128, v129
    v_cvt_pk_bf16_f32 v129, v130, v131
    v_mfma_f32_32x32x16_bf16 v[224:239], a[204:207], v[68:71], v[224:239]
    v_cvt_pk_bf16_f32 v130, v132, v133
    v_cvt_pk_bf16_f32 v131, v134, v135
    s_nop 0
    v_permlane32_swap_b32 v128, v130
    v_permlane32_swap_b32 v129, v131
    buffer_store_dwordx4 v[128:131], v12, s[28:31], s76 offen offset:0 sc1
    v_mfma_f32_32x32x16_bf16 v[208:223], a[200:203], v[100:103], v[208:223]
    v_cvt_pk_bf16_f32 v136, v136, v137
    v_cvt_pk_bf16_f32 v137, v138, v139
    v_mfma_f32_32x32x16_bf16 v[240:255], a[204:207], v[100:103], v[240:255]
    v_cvt_pk_bf16_f32 v138, v140, v141
    v_cvt_pk_bf16_f32 v139, v142, v143
    s_nop 0
    v_permlane32_swap_b32 v136, v138
    v_permlane32_swap_b32 v137, v139
    buffer_store_dwordx4 v[136:139], v12, s[28:31], s76 offen offset:1024 sc1
    s_waitcnt lgkmcnt(0)
    v_mfma_f32_32x32x16_bf16 v[192:207], v[32:35], v[72:75], v[192:207]
    s_add_u32 s75, s75, 40960
    s_add_u32 m0, s64, 0
    s_nop 0
    buffer_load_dwordx4 v2, s[24:27], s75 offen offset:0  lds
    v_mfma_f32_32x32x16_bf16 v[224:239], v[36:39], v[72:75], v[224:239]
    buffer_load_dwordx4 v3, s[24:27], s75 offen offset:1024  lds
    s_waitcnt vmcnt(20)
    ds_read_b64_tr_b16 a[240:241], v6 offset:4096
    ds_read_b64_tr_b16 a[242:243], v6 offset:5120
    v_mfma_f32_32x32x16_bf16 v[208:223], v[32:35], v[104:107], v[208:223]
    buffer_load_dwordx4 v4, s[24:27], s75 offen offset:2048  lds
    ds_read_b64_tr_b16 a[244:245], v7 offset:4096
    ds_read_b64_tr_b16 a[246:247], v7 offset:5120
    v_mfma_f32_32x32x16_bf16 v[240:255], v[36:39], v[104:107], v[240:255]
    buffer_load_dwordx4 v5, s[24:27], s75 offen offset:3072  lds
    ds_read_b64_tr_b16 a[248:249], v6 offset:6144
    ds_read_b64_tr_b16 a[250:251], v6 offset:7168
    v_mfma_f32_32x32x16_bf16 v[192:207], v[40:43], v[76:79], v[192:207]
    ds_read_b64_tr_b16 a[252:253], v7 offset:6144
    ds_read_b64_tr_b16 a[254:255], v7 offset:7168
    v_cvt_pk_bf16_f32 v144, v144, v145
    v_cvt_pk_bf16_f32 v145, v146, v147
    v_mfma_f32_32x32x16_bf16 v[224:239], v[44:47], v[76:79], v[224:239]
    v_cvt_pk_bf16_f32 v146, v148, v149
    v_cvt_pk_bf16_f32 v147, v150, v151
    s_nop 0
    v_permlane32_swap_b32 v144, v146
    v_permlane32_swap_b32 v145, v147
    buffer_store_dwordx4 v[144:147], v12, s[28:31], s76 offen offset:2048 sc1
    v_mfma_f32_32x32x16_bf16 v[208:223], v[40:43], v[108:111], v[208:223]
    v_cvt_pk_bf16_f32 v152, v152, v153
    v_cvt_pk_bf16_f32 v153, v154, v155
    v_mfma_f32_32x32x16_bf16 v[240:255], v[44:47], v[108:111], v[240:255]
    v_cvt_pk_bf16_f32 v154, v156, v157
    v_cvt_pk_bf16_f32 v155, v158, v159
    s_nop 0
    v_permlane32_swap_b32 v152, v154
    v_permlane32_swap_b32 v153, v155
    buffer_store_dwordx4 v[152:155], v12, s[28:31], s76 offen offset:3072 sc1
    s_waitcnt lgkmcnt(0)
    v_mfma_f32_32x32x16_bf16 v[192:207], v[48:51], v[80:83], v[192:207]
    s_add_u32 s75, s75, 40960
    s_add_u32 m0, s64, 4096
    s_nop 0
    buffer_load_dwordx4 v2, s[24:27], s75 offen offset:0  lds
    v_mfma_f32_32x32x16_bf16 v[224:239], v[52:55], v[80:83], v[224:239]
    buffer_load_dwordx4 v3, s[24:27], s75 offen offset:1024  lds
    s_waitcnt vmcnt(22)
    ds_read_b64_tr_b16 v[32:33], v6 offset:8192
    ds_read_b64_tr_b16 v[34:35], v6 offset:9216
    v_mfma_f32_32x32x16_bf16 v[208:223], v[48:51], v[112:115], v[208:223]
    buffer_load_dwordx4 v4, s[24:27], s75 offen offset:2048  lds
    ds_read_b64_tr_b16 v[36:37], v7 offset:8192
    ds_read_b64_tr_b16 v[38:39], v7 offset:9216
    v_mfma_f32_32x32x16_bf16 v[240:255], v[52:55], v[112:115], v[240:255]
    buffer_load_dwordx4 v5, s[24:27], s75 offen offset:3072  lds
    ds_read_b64_tr_b16 v[40:41], v6 offset:10240
    ds_read_b64_tr_b16 v[42:43], v6 offset:11264
    v_mfma_f32_32x32x16_bf16 v[192:207], v[56:59], v[84:87], v[192:207]
    ds_read_b64_tr_b16 v[44:45], v7 offset:10240
    ds_read_b64_tr_b16 v[46:47], v7 offset:11264
    v_cvt_pk_bf16_f32 v160, v160, v161
    v_cvt_pk_bf16_f32 v161, v162, v163
    v_mfma_f32_32x32x16_bf16 v[224:239], v[60:63], v[84:87], v[224:239]
    v_cvt_pk_bf16_f32 v162, v164, v165
    v_cvt_pk_bf16_f32 v163, v166, v167
    s_nop 0
    v_permlane32_swap_b32 v160, v162
    v_permlane32_swap_b32 v161, v163
    s_add_u32 s76, s76, 4096
    buffer_store_dwordx4 v[160:163], v12, s[28:31], s76 offen offset:0 sc1
    v_mfma_f32_32x32x16_bf16 v[208:223], v[56:59], v[116:119], v[208:223]
    v_cvt_pk_bf16_f32 v168, v168, v169
    v_cvt_pk_bf16_f32 v169, v170, v171
    v_mfma_f32_32x32x16_bf16 v[240:255], v[60:63], v[116:119], v[240:255]
    v_cvt_pk_bf16_f32 v170, v172, v173
    v_cvt_pk_bf16_f32 v171, v174, v175
    s_nop 0
    v_permlane32_swap_b32 v168, v170
    v_permlane32_swap_b32 v169, v171
    buffer_store_dwordx4 v[168:171], v12, s[28:31], s76 offen offset:1024 sc1
    s_waitcnt lgkmcnt(0)
    v_mfma_f32_32x32x16_bf16 v[192:207], a[208:211], v[88:91], v[192:207]
    s_add_u32 s75, s71, s73
    s_add_u32 m0, s64, 8192
    s_nop 0
    buffer_load_dwordx4 v2, s[24:27], s75 offen offset:0  lds
    v_mfma_f32_32x32x16_bf16 v[224:239], a[212:215], v[88:91], v[224:239]
    buffer_load_dwordx4 v3, s[24:27], s75 offen offset:1024  lds
    v_mfma_f32_32x32x16_bf16 v[208:223], a[208:211], v[120:123], v[208:223]
    buffer_load_dwordx4 v4, s[24:27], s75 offen offset:2048  lds
    v_mfma_f32_32x32x16_bf16 v[240:255], a[212:215], v[120:123], v[240:255]
    buffer_load_dwordx4 v5, s[24:27], s75 offen offset:3072  lds
    v_mfma_f32_32x32x16_bf16 v[192:207], a[216:219], v[92:95], v[192:207]
    v_cvt_pk_bf16_f32 v176, v176, v177
    v_cvt_pk_bf16_f32 v177, v178, v179
    v_mfma_f32_32x32x16_bf16 v[224:239], a[220:223], v[92:95], v[224:239]
    v_cvt_pk_bf16_f32 v178, v180, v181
    v_cvt_pk_bf16_f32 v179, v182, v183
    s_nop 0
    v_permlane32_swap_b32 v176, v178
    v_permlane32_swap_b32 v177, v179
    buffer_store_dwordx4 v[176:179], v12, s[28:31], s76 offen offset:2048 sc1
    v_mfma_f32_32x32x16_bf16 v[208:223], a[216:219], v[124:127], v[208:223]
    v_cvt_pk_bf16_f32 v184, v184, v185
    v_cvt_pk_bf16_f32 v185, v186, v187
    v_mfma_f32_32x32x16_bf16 v[240:255], a[220:223], v[124:127], v[240:255]
    v_cvt_pk_bf16_f32 v186, v188, v189
    v_cvt_pk_bf16_f32 v187, v190, v191
    s_nop 0
    v_permlane32_swap_b32 v184, v186
    v_permlane32_swap_b32 v185, v187
    buffer_store_dwordx4 v[184:187], v12, s[28:31], s76 offen offset:3072 sc1
    v_mfma_f32_32x32x16_bf16 v[192:207], a[224:227], a[0:3], v[192:207]
    v_mfma_f32_32x32x16_bf16 v[224:239], a[228:231], a[0:3], v[224:239]
    s_waitcnt vmcnt(28)
    ds_read_b64_tr_b16 v[48:49], v6 offset:12288
    ds_read_b64_tr_b16 v[50:51], v6 offset:13312
    v_mfma_f32_32x32x16_bf16 v[208:223], a[224:227], a[32:35], v[208:223]
    ds_read_b64_tr_b16 v[52:53], v7 offset:12288
    ds_read_b64_tr_b16 v[54:55], v7 offset:13312
    v_mfma_f32_32x32x16_bf16 v[240:255], a[228:231], a[32:35], v[240:255]
    ds_read_b64_tr_b16 v[56:57], v6 offset:14336
    ds_read_b64_tr_b16 v[58:59], v6 offset:15360
    v_mfma_f32_32x32x16_bf16 v[192:207], a[232:235], a[4:7], v[192:207]
    ds_read_b64_tr_b16 v[60:61], v7 offset:14336
    ds_read_b64_tr_b16 v[62:63], v7 offset:15360
    v_mfma_f32_32x32x16_bf16 v[224:239], a[236:239], a[4:7], v[224:239]
    v_mfma_f32_32x32x16_bf16 v[208:223], a[232:235], a[36:39], v[208:223]
    v_mfma_f32_32x32x16_bf16 v[240:255], a[236:239], a[36:39], v[240:255]
    s_waitcnt lgkmcnt(0)
    v_mfma_f32_32x32x16_bf16 v[192:207], a[240:243], a[8:11], v[192:207]
    s_add_u32 s75, s75, 40960
    s_add_u32 m0, s64, 12288
    s_nop 0
    buffer_load_dwordx4 v2, s[24:27], s75 offen offset:0  lds
    v_mfma_f32_32x32x16_bf16 v[224:239], a[244:247], a[8:11], v[224:239]
    buffer_load_dwordx4 v3, s[24:27], s75 offen offset:1024  lds
    s_waitcnt vmcnt(26)
    ds_read_b64_tr_b16 a[192:193], v6 offset:16384
    ds_read_b64_tr_b16 a[194:195], v6 offset:17408
    v_mfma_f32_32x32x16_bf16 v[208:223], a[240:243], a[40:43], v[208:223]
    buffer_load_dwordx4 v4, s[24:27], s75 offen offset:2048  lds
    ds_read_b64_tr_b16 a[196:197], v7 offset:16384
    ds_read_b64_tr_b16 a[198:199], v7 offset:17408
    v_mfma_f32_32x32x16_bf16 v[240:255], a[244:247], a[40:43], v[240:255]
    buffer_load_dwordx4 v5, s[24:27], s75 offen offset:3072  lds
    ds_read_b64_tr_b16 a[200:201], v6 offset:18432
    ds_read_b64_tr_b16 a[202:203], v6 offset:19456
    v_mfma_f32_32x32x16_bf16 v[192:207], a[248:251], a[12:15], v[192:207]
    ds_read_b64_tr_b16 a[204:205], v7 offset:18432
    ds_read_b64_tr_b16 a[206:207], v7 offset:19456
    v_mfma_f32_32x32x16_bf16 v[224:239], a[252:255], a[12:15], v[224:239]
    v_mfma_f32_32x32x16_bf16 v[208:223], a[248:251], a[44:47], v[208:223]
    v_mfma_f32_32x32x16_bf16 v[240:255], a[252:255], a[44:47], v[240:255]
    s_waitcnt lgkmcnt(0)
    v_mfma_f32_32x32x16_bf16 v[192:207], v[32:35], a[16:19], v[192:207]
    s_add_u32 s75, s75, 40960
    s_add_u32 m0, s64, 16384
    s_nop 0
    buffer_load_dwordx4 v2, s[24:27], s75 offen offset:0  lds
    v_mfma_f32_32x32x16_bf16 v[224:239], v[36:39], a[16:19], v[224:239]
    buffer_load_dwordx4 v3, s[24:27], s75 offen offset:1024  lds
    s_waitcnt vmcnt(26)
    ds_read_b64_tr_b16 a[208:209], v6 offset:20480
    ds_read_b64_tr_b16 a[210:211], v6 offset:21504
    v_mfma_f32_32x32x16_bf16 v[208:223], v[32:35], a[48:51], v[208:223]
    buffer_load_dwordx4 v4, s[24:27], s75 offen offset:2048  lds
    ds_read_b64_tr_b16 a[212:213], v7 offset:20480
    ds_read_b64_tr_b16 a[214:215], v7 offset:21504
    v_mfma_f32_32x32x16_bf16 v[240:255], v[36:39], a[48:51], v[240:255]
    buffer_load_dwordx4 v5, s[24:27], s75 offen offset:3072  lds
    ds_read_b64_tr_b16 a[216:217], v6 offset:22528
    ds_read_b64_tr_b16 a[218:219], v6 offset:23552
    v_mfma_f32_32x32x16_bf16 v[192:207], v[40:43], a[20:23], v[192:207]
    ds_read_b64_tr_b16 a[220:221], v7 offset:22528
    ds_read_b64_tr_b16 a[222:223], v7 offset:23552
    v_mfma_f32_32x32x16_bf16 v[224:239], v[44:47], a[20:23], v[224:239]
    v_mfma_f32_32x32x16_bf16 v[208:223], v[40:43], a[52:55], v[208:223]
    v_mfma_f32_32x32x16_bf16 v[240:255], v[44:47], a[52:55], v[240:255]
    s_waitcnt lgkmcnt(0)
    v_mfma_f32_32x32x16_bf16 v[192:207], v[48:51], a[24:27], v[192:207]
    s_add_u32 s75, s75, 40960
    s_add_u32 m0, s64, 20480
    s_nop 0
    buffer_load_dwordx4 v2, s[24:27], s75 offen offset:0  lds
    v_mfma_f32_32x32x16_bf16 v[224:239], v[52:55], a[24:27], v[224:239]
    buffer_load_dwordx4 v3, s[24:27], s75 offen offset:1024  lds
    s_waitcnt vmcnt(24)
    ds_read_b64_tr_b16 v[32:33], v6 offset:0
    ds_read_b64_tr_b16 v[34:35], v6 offset:1024
    v_mfma_f32_32x32x16_bf16 v[208:223], v[48:51], a[56:59], v[208:223]
    buffer_load_dwordx4 v4, s[24:27], s75 offen offset:2048  lds
    ds_read_b64_tr_b16 v[36:37], v7 offset:0
    ds_read_b64_tr_b16 v[38:39], v7 offset:1024
    v_mfma_f32_32x32x16_bf16 v[240:255], v[52:55], a[56:59], v[240:255]
    buffer_load_dwordx4 v5, s[24:27], s75 offen offset:3072  lds
    ds_read_b64_tr_b16 v[40:41], v6 offset:2048
    ds_read_b64_tr_b16 v[42:43], v6 offset:3072
    v_mfma_f32_32x32x16_bf16 v[192:207], v[56:59], a[28:31], v[192:207]
    ds_read_b64_tr_b16 v[44:45], v7 offset:2048
    ds_read_b64_tr_b16 v[46:47], v7 offset:3072
    v_mfma_f32_32x32x16_bf16 v[224:239], v[60:63], a[28:31], v[224:239]
    v_mfma_f32_32x32x16_bf16 v[208:223], v[56:59], a[60:63], v[208:223]
    v_mfma_f32_32x32x16_bf16 v[240:255], v[60:63], a[60:63], v[240:255]
    s_waitcnt lgkmcnt(0)
    v_mfma_f32_32x32x16_bf16 v[192:207], a[192:195], a[64:67], v[192:207]
    s_add_u32 s75, s68, s74
    s_add_u32 m0, s64, 0
    s_nop 0
    buffer_load_dwordx4 v2, s[24:27], s75 offen offset:0  lds
    v_mfma_f32_32x32x16_bf16 v[224:239], a[196:199], a[64:67], v[224:239]
    buffer_load_dwordx4 v3, s[24:27], s75 offen offset:1024  lds
    s_waitcnt vmcnt(22)
    ds_read_b64_tr_b16 v[48:49], v6 offset:4096
    ds_read_b64_tr_b16 v[50:51], v6 offset:5120
    v_mfma_f32_32x32x16_bf16 v[208:223], a[192:195], a[96:99], v[208:223]
    buffer_load_dwordx4 v4, s[24:27], s75 offen offset:2048  lds
    ds_read_b64_tr_b16 v[52:53], v7 offset:4096
    ds_read_b64_tr_b16 v[54:55], v7 offset:5120
    v_mfma_f32_32x32x16_bf16 v[240:255], a[196:199], a[96:99], v[240:255]
    buffer_load_dwordx4 v5, s[24:27], s75 offen offset:3072  lds
    ds_read_b64_tr_b16 v[56:57], v6 offset:6144
    ds_read_b64_tr_b16 v[58:59], v6 offset:7168
    v_mfma_f32_32x32x16_bf16 v[192:207], a[200:203], a[68:71], v[192:207]
    ds_read_b64_tr_b16 v[60:61], v7 offset:6144
    ds_read_b64_tr_b16 v[62:63], v7 offset:7168
    v_mfma_f32_32x32x16_bf16 v[224:239], a[204:207], a[68:71], v[224:239]
    v_mfma_f32_32x32x16_bf16 v[208:223], a[200:203], a[100:103], v[208:223]
    v_mfma_f32_32x32x16_bf16 v[240:255], a[204:207], a[100:103], v[240:255]
    s_waitcnt lgkmcnt(0)
    v_mfma_f32_32x32x16_bf16 v[192:207], a[208:211], a[72:75], v[192:207]
    s_add_u32 s75, s75, 40960
    s_add_u32 m0, s64, 4096
    s_nop 0
    buffer_load_dwordx4 v2, s[24:27], s75 offen offset:0  lds
    v_mfma_f32_32x32x16_bf16 v[224:239], a[212:215], a[72:75], v[224:239]
    buffer_load_dwordx4 v3, s[24:27], s75 offen offset:1024  lds
    s_waitcnt vmcnt(20)
    ds_read_b64_tr_b16 a[224:225], v6 offset:8192
    ds_read_b64_tr_b16 a[226:227], v6 offset:9216
    v_mfma_f32_32x32x16_bf16 v[208:223], a[208:211], a[104:107], v[208:223]
    buffer_load_dwordx4 v4, s[24:27], s75 offen offset:2048  lds
    ds_read_b64_tr_b16 a[228:229], v7 offset:8192
    ds_read_b64_tr_b16 a[230:231], v7 offset:9216
    v_mfma_f32_32x32x16_bf16 v[240:255], a[212:215], a[104:107], v[240:255]
    buffer_load_dwordx4 v5, s[24:27], s75 offen offset:3072  lds
    ds_read_b64_tr_b16 a[232:233], v6 offset:10240
    ds_read_b64_tr_b16 a[234:235], v6 offset:11264
    v_mfma_f32_32x32x16_bf16 v[192:207], a[216:219], a[76:79], v[192:207]
    ds_read_b64_tr_b16 a[236:237], v7 offset:10240
    ds_read_b64_tr_b16 a[238:239], v7 offset:11264
    v_mfma_f32_32x32x16_bf16 v[224:239], a[220:223], a[76:79], v[224:239]
    v_mfma_f32_32x32x16_bf16 v[208:223], a[216:219], a[108:111], v[208:223]
    v_mfma_f32_32x32x16_bf16 v[240:255], a[220:223], a[108:111], v[240:255]
    s_waitcnt lgkmcnt(0)
    v_mfma_f32_32x32x16_bf16 v[192:207], v[32:35], a[80:83], v[192:207]
    s_add_u32 s75, s75, 40960
    s_add_u32 m0, s64, 8192
    s_nop 0
    buffer_load_dwordx4 v2, s[24:27], s75 offen offset:0  lds
    v_mfma_f32_32x32x16_bf16 v[224:239], v[36:39], a[80:83], v[224:239]
    buffer_load_dwordx4 v3, s[24:27], s75 offen offset:1024  lds
    s_waitcnt vmcnt(18)
    ds_read_b64_tr_b16 a[240:241], v6 offset:12288
    ds_read_b64_tr_b16 a[242:243], v6 offset:13312
    v_mfma_f32_32x32x16_bf16 v[208:223], v[32:35], a[112:115], v[208:223]
    buffer_load_dwordx4 v4, s[24:27], s75 offen offset:2048  lds
    ds_read_b64_tr_b16 a[244:245], v7 offset:12288
    ds_read_b64_tr_b16 a[246:247], v7 offset:13312
    buffer_atomic_or v17, v14, s[28:31], s50 offen offset:0 sc1
    v_mfma_f32_32x32x16_bf16 v[240:255], v[36:39], a[112:115], v[240:255]
    buffer_load_dwordx4 v5, s[24:27], s75 offen offset:3072  lds
    ds_read_b64_tr_b16 a[248:249], v6 offset:14336
    ds_read_b64_tr_b16 a[250:251], v6 offset:15360
    v_mfma_f32_32x32x16_bf16 v[192:207], v[40:43], a[84:87], v[192:207]
    ds_read_b64_tr_b16 a[252:253], v7 offset:14336
    ds_read_b64_tr_b16 a[254:255], v7 offset:15360
    v_mfma_f32_32x32x16_bf16 v[224:239], v[44:47], a[84:87], v[224:239]
    v_mfma_f32_32x32x16_bf16 v[208:223], v[40:43], a[116:119], v[208:223]
    v_mfma_f32_32x32x16_bf16 v[240:255], v[44:47], a[116:119], v[240:255]
    s_waitcnt lgkmcnt(0)
    v_mfma_f32_32x32x16_bf16 v[192:207], v[48:51], a[88:91], v[192:207]
    s_add_u32 s75, s75, 40960
    s_add_u32 m0, s64, 12288
    s_nop 0
    buffer_load_dwordx4 v2, s[24:27], s75 offen offset:0  lds
    v_mfma_f32_32x32x16_bf16 v[224:239], v[52:55], a[88:91], v[224:239]
    buffer_load_dwordx4 v3, s[24:27], s75 offen offset:1024  lds
    s_waitcnt vmcnt(19)
    ds_read_b64_tr_b16 v[32:33], v6 offset:16384
    ds_read_b64_tr_b16 v[34:35], v6 offset:17408
    v_mfma_f32_32x32x16_bf16 v[208:223], v[48:51], a[120:123], v[208:223]
    buffer_load_dwordx4 v4, s[24:27], s75 offen offset:2048  lds
    ds_read_b64_tr_b16 v[36:37], v7 offset:16384
    ds_read_b64_tr_b16 v[38:39], v7 offset:17408
    v_mfma_f32_32x32x16_bf16 v[240:255], v[52:55], a[120:123], v[240:255]
    buffer_load_dwordx4 v5, s[24:27], s75 offen offset:3072  lds
    ds_read_b64_tr_b16 v[40:41], v6 offset:18432
    ds_read_b64_tr_b16 v[42:43], v6 offset:19456
    v_mfma_f32_32x32x16_bf16 v[192:207], v[56:59], a[92:95], v[192:207]
    ds_read_b64_tr_b16 v[44:45], v7 offset:18432
    ds_read_b64_tr_b16 v[46:47], v7 offset:19456
    v_mfma_f32_32x32x16_bf16 v[224:239], v[60:63], a[92:95], v[224:239]
    v_mfma_f32_32x32x16_bf16 v[208:223], v[56:59], a[124:127], v[208:223]
    v_mfma_f32_32x32x16_bf16 v[240:255], v[60:63], a[124:127], v[240:255]
    s_waitcnt lgkmcnt(0)
    v_mfma_f32_32x32x16_bf16 v[192:207], a[224:227], a[128:131], v[192:207]
    s_add_u32 s75, s70, s74
    s_add_u32 m0, s64, 16384
    s_nop 0
    buffer_load_dwordx4 v2, s[24:27], s75 offen offset:0  lds
    v_mfma_f32_32x32x16_bf16 v[224:239], a[228:231], a[128:131], v[224:239]
    buffer_load_dwordx4 v3, s[24:27], s75 offen offset:1024  lds
    v_mfma_f32_32x32x16_bf16 v[208:223], a[224:227], a[160:163], v[208:223]
    buffer_load_dwordx4 v4, s[24:27], s75 offen offset:2048  lds
    v_mfma_f32_32x32x16_bf16 v[240:255], a[228:231], a[160:163], v[240:255]
    buffer_load_dwordx4 v5, s[24:27], s75 offen offset:3072  lds
    v_mfma_f32_32x32x16_bf16 v[192:207], a[232:235], a[132:135], v[192:207]
    v_mfma_f32_32x32x16_bf16 v[224:239], a[236:239], a[132:135], v[224:239]
    v_mfma_f32_32x32x16_bf16 v[208:223], a[232:235], a[164:167], v[208:223]
    v_mfma_f32_32x32x16_bf16 v[240:255], a[236:239], a[164:167], v[240:255]
    v_mfma_f32_32x32x16_bf16 v[192:207], a[240:243], a[136:139], v[192:207]
    v_mfma_f32_32x32x16_bf16 v[224:239], a[244:247], a[136:139], v[224:239]
    s_waitcnt vmcnt(21)
    ds_read_b64_tr_b16 v[48:49], v6 offset:20480
    ds_read_b64_tr_b16 v[50:51], v6 offset:21504
    v_mfma_f32_32x32x16_bf16 v[208:223], a[240:243], a[168:171], v[208:223]
    ds_read_b64_tr_b16 v[52:53], v7 offset:20480
    ds_read_b64_tr_b16 v[54:55], v7 offset:21504
    v_mfma_f32_32x32x16_bf16 v[240:255], a[244:247], a[168:171], v[240:255]
    ds_read_b64_tr_b16 v[56:57], v6 offset:22528
    ds_read_b64_tr_b16 v[58:59], v6 offset:23552
    v_mfma_f32_32x32x16_bf16 v[192:207], a[248:251], a[140:143], v[192:207]
    ds_read_b64_tr_b16 v[60:61], v7 offset:22528
    ds_read_b64_tr_b16 v[62:63], v7 offset:23552
    v_mfma_f32_32x32x16_bf16 v[224:239], a[252:255], a[140:143], v[224:239]
    v_mfma_f32_32x32x16_bf16 v[208:223], a[248:251], a[172:175], v[208:223]
    v_mfma_f32_32x32x16_bf16 v[240:255], a[252:255], a[172:175], v[240:255]
    s_waitcnt lgkmcnt(0)
    v_mfma_f32_32x32x16_bf16 v[192:207], v[32:35], a[144:147], v[192:207]
    s_add_u32 s75, s75, 40960
    s_add_u32 m0, s64, 20480
    s_nop 0
    buffer_load_dwordx4 v2, s[24:27], s75 offen offset:0  lds
    v_mfma_f32_32x32x16_bf16 v[224:239], v[36:39], a[144:147], v[224:239]
    buffer_load_dwordx4 v3, s[24:27], s75 offen offset:1024  lds
    s_waitcnt vmcnt(19)
    ds_read_b64_tr_b16 a[192:193], v6 offset:0
    ds_read_b64_tr_b16 a[194:195], v6 offset:1024
    v_mfma_f32_32x32x16_bf16 v[208:223], v[32:35], a[176:179], v[208:223]
    buffer_load_dwordx4 v4, s[24:27], s75 offen offset:2048  lds
    ds_read_b64_tr_b16 a[196:197], v7 offset:0
    ds_read_b64_tr_b16 a[198:199], v7 offset:1024
    v_mfma_f32_32x32x16_bf16 v[240:255], v[36:39], a[176:179], v[240:255]
    buffer_load_dwordx4 v5, s[24:27], s75 offen offset:3072  lds
    ds_read_b64_tr_b16 a[200:201], v6 offset:2048
    ds_read_b64_tr_b16 a[202:203], v6 offset:3072
    v_mfma_f32_32x32x16_bf16 v[192:207], v[40:43], a[148:151], v[192:207]
    ds_read_b64_tr_b16 a[204:205], v7 offset:2048
    ds_read_b64_tr_b16 a[206:207], v7 offset:3072
    v_mfma_f32_32x32x16_bf16 v[224:239], v[44:47], a[148:151], v[224:239]
    v_mfma_f32_32x32x16_bf16 v[208:223], v[40:43], a[180:183], v[208:223]
    v_mfma_f32_32x32x16_bf16 v[240:255], v[44:47], a[180:183], v[240:255]
    s_waitcnt lgkmcnt(0)
    v_mfma_f32_32x32x16_bf16 v[192:207], v[48:51], a[152:155], v[192:207]
    s_add_u32 s75, s75, 40960
    s_add_u32 m0, s64, 0
    s_nop 0
    buffer_load_dwordx4 v2, s[24:27], s75 offen offset:0  lds
    v_mfma_f32_32x32x16_bf16 v[224:239], v[52:55], a[152:155], v[224:239]
    buffer_load_dwordx4 v3, s[24:27], s75 offen offset:1024  lds
    s_waitcnt vmcnt(19)
    ds_read_b64_tr_b16 v[32:33], v6 offset:4096
    ds_read_b64_tr_b16 v[34:35], v6 offset:5120
    v_mfma_f32_32x32x16_bf16 v[208:223], v[48:51], a[184:187], v[208:223]
    buffer_load_dwordx4 v4, s[24:27], s75 offen offset:2048  lds
    ds_read_b64_tr_b16 v[36:37], v7 offset:4096
    ds_read_b64_tr_b16 v[38:39], v7 offset:5120
    v_mfma_f32_32x32x16_bf16 v[240:255], v[52:55], a[184:187], v[240:255]
    buffer_load_dwordx4 v5, s[24:27], s75 offen offset:3072  lds
    ds_read_b64_tr_b16 v[40:41], v6 offset:6144
    ds_read_b64_tr_b16 v[42:43], v6 offset:7168
    v_mfma_f32_32x32x16_bf16 v[192:207], v[56:59], a[156:159], v[192:207]
    ds_read_b64_tr_b16 v[44:45], v7 offset:6144
    ds_read_b64_tr_b16 v[46:47], v7 offset:7168
    v_mfma_f32_32x32x16_bf16 v[224:239], v[60:63], a[156:159], v[224:239]
    v_mfma_f32_32x32x16_bf16 v[208:223], v[56:59], a[188:191], v[208:223]
    v_mfma_f32_32x32x16_bf16 v[240:255], v[60:63], a[188:191], v[240:255]
    s_waitcnt lgkmcnt(0)
    v_mfma_f32_32x32x16_bf16 v[128:143], a[192:195], v[64:67], 0
    s_add_u32 s75, s75, 40960
    s_add_u32 m0, s64, 4096
    s_nop 0
    buffer_load_dwordx4 v2, s[24:27], s75 offen offset:0  lds
    v_mfma_f32_32x32x16_bf16 v[160:175], a[196:199], v[64:67], 0
    buffer_load_dwordx4 v3, s[24:27], s75 offen offset:1024  lds
    s_waitcnt vmcnt(18)
    ds_read_b64_tr_b16 v[48:49], v6 offset:8192
    ds_read_b64_tr_b16 v[50:51], v6 offset:9216
    v_mfma_f32_32x32x16_bf16 v[144:159], a[192:195], v[96:99], 0
    buffer_load_dwordx4 v4, s[24:27], s75 offen offset:2048  lds
    ds_read_b64_tr_b16 v[52:53], v7 offset:8192
    ds_read_b64_tr_b16 v[54:55], v7 offset:9216
    v_mfma_f32_32x32x16_bf16 v[176:191], a[196:199], v[96:99], 0
    buffer_load_dwordx4 v5, s[24:27], s75 offen offset:3072  lds
    ds_read_b64_tr_b16 v[56:57], v6 offset:10240
    ds_read_b64_tr_b16 v[58:59], v6 offset:11264
    v_mfma_f32_32x32x16_bf16 v[128:143], a[200:203], v[68:71], v[128:143]
    ds_read_b64_tr_b16 v[60:61], v7 offset:10240
    ds_read_b64_tr_b16 v[62:63], v7 offset:11264
    v_cvt_pk_bf16_f32 v192, v192, v193
    v_cvt_pk_bf16_f32 v193, v194, v195
    v_mfma_f32_32x32x16_bf16 v[160:175], a[204:207], v[68:71], v[160:175]
    v_cvt_pk_bf16_f32 v194, v196, v197
    v_cvt_pk_bf16_f32 v195, v198, v199
    s_nop 0
    v_permlane32_swap_b32 v192, v194
    v_permlane32_swap_b32 v193, v195
    buffer_store_dwordx4 v[192:195], v12, s[28:31], s77 offen offset:0 sc1
    v_mfma_f32_32x32x16_bf16 v[144:159], a[200:203], v[100:103], v[144:159]
    v_cvt_pk_bf16_f32 v200, v200, v201
    v_cvt_pk_bf16_f32 v201, v202, v203
    v_mfma_f32_32x32x16_bf16 v[176:191], a[204:207], v[100:103], v[176:191]
    v_cvt_pk_bf16_f32 v202, v204, v205
    v_cvt_pk_bf16_f32 v203, v206, v207
    s_nop 0
    v_permlane32_swap_b32 v200, v202
    v_permlane32_swap_b32 v201, v203
    buffer_store_dwordx4 v[200:203], v12, s[28:31], s77 offen offset:1024 sc1
    s_waitcnt lgkmcnt(0)
    v_mfma_f32_32x32x16_bf16 v[128:143], v[32:35], v[72:75], v[128:143]
    v_mfma_f32_32x32x16_bf16 v[160:175], v[36:39], v[72:75], v[160:175]
    s_waitcnt vmcnt(18)
    ds_read_b64_tr_b16 a[208:209], v6 offset:12288
    ds_read_b64_tr_b16 a[210:211], v6 offset:13312
    v_mfma_f32_32x32x16_bf16 v[144:159], v[32:35], v[104:107], v[144:159]
    ds_read_b64_tr_b16 a[212:213], v7 offset:12288
    ds_read_b64_tr_b16 a[214:215], v7 offset:13312
    v_mfma_f32_32x32x16_bf16 v[176:191], v[36:39], v[104:107], v[176:191]
    ds_read_b64_tr_b16 a[216:217], v6 offset:14336
    ds_read_b64_tr_b16 a[218:219], v6 offset:15360
    v_mfma_f32_32x32x16_bf16 v[128:143], v[40:43], v[76:79], v[128:143]
    ds_read_b64_tr_b16 a[220:221], v7 offset:14336
    ds_read_b64_tr_b16 a[222:223], v7 offset:15360
    v_cvt_pk_bf16_f32 v208, v208, v209
    v_cvt_pk_bf16_f32 v209, v210, v211
    v_mfma_f32_32x32x16_bf16 v[160:175], v[44:47], v[76:79], v[160:175]
    v_cvt_pk_bf16_f32 v210, v212, v213
    v_cvt_pk_bf16_f32 v211, v214, v215
    s_nop 0
    v_permlane32_swap_b32 v208, v210
    v_permlane32_swap_b32 v209, v211
    buffer_store_dwordx4 v[208:211], v12, s[28:31], s77 offen offset:2048 sc1
    v_mfma_f32_32x32x16_bf16 v[144:159], v[40:43], v[108:111], v[144:159]
    v_cvt_pk_bf16_f32 v216, v216, v217
    v_cvt_pk_bf16_f32 v217, v218, v219
    v_mfma_f32_32x32x16_bf16 v[176:191], v[44:47], v[108:111], v[176:191]
    v_cvt_pk_bf16_f32 v218, v220, v221
    v_cvt_pk_bf16_f32 v219, v222, v223
    s_nop 0
    v_permlane32_swap_b32 v216, v218
    v_permlane32_swap_b32 v217, v219
    buffer_store_dwordx4 v[216:219], v12, s[28:31], s77 offen offset:3072 sc1
    v_mov_b32 v16, 0
    buffer_atomic_or v16, v18, s[28:31], s51 offen sc0 sc1
    s_waitcnt lgkmcnt(0)
    v_mfma_f32_32x32x16_bf16 v[128:143], v[48:51], v[80:83], v[128:143]
    v_mfma_f32_32x32x16_bf16 v[160:175], v[52:55], v[80:83], v[160:175]
    s_waitcnt vmcnt(17)
    ds_read_b64_tr_b16 a[224:225], v6 offset:16384
    ds_read_b64_tr_b16 a[226:227], v6 offset:17408
    v_mfma_f32_32x32x16_bf16 v[144:159], v[48:51], v[112:115], v[144:159]
    ds_read_b64_tr_b16 a[228:229], v7 offset:16384
    ds_read_b64_tr_b16 a[230:231], v7 offset:17408
    v_mfma_f32_32x32x16_bf16 v[176:191], v[52:55], v[112:115], v[176:191]
    ds_read_b64_tr_b16 a[232:233], v6 offset:18432
    ds_read_b64_tr_b16 a[234:235], v6 offset:19456
    v_mfma_f32_32x32x16_bf16 v[128:143], v[56:59], v[84:87], v[128:143]
    ds_read_b64_tr_b16 a[236:237], v7 offset:18432
    ds_read_b64_tr_b16 a[238:239], v7 offset:19456
    v_cvt_pk_bf16_f32 v224, v224, v225
    v_cvt_pk_bf16_f32 v225, v226, v227
    v_mfma_f32_32x32x16_bf16 v[160:175], v[60:63], v[84:87], v[160:175]
    v_cvt_pk_bf16_f32 v226, v228, v229
    v_cvt_pk_bf16_f32 v227, v230, v231
    s_nop 0
    v_permlane32_swap_b32 v224, v226
    v_permlane32_swap_b32 v225, v227
    s_add_u32 s77, s77, 4096
    buffer_store_dwordx4 v[224:227], v12, s[28:31], s77 offen offset:0 sc1
    v_mfma_f32_32x32x16_bf16 v[144:159], v[56:59], v[116:119], v[144:159]
    v_cvt_pk_bf16_f32 v232, v232, v233
    v_cvt_pk_bf16_f32 v233, v234, v235
    v_mfma_f32_32x32x16_bf16 v[176:191], v[60:63], v[116:119], v[176:191]
    v_cvt_pk_bf16_f32 v234, v236, v237
    v_cvt_pk_bf16_f32 v235, v238, v239
    s_nop 0
    v_permlane32_swap_b32 v232, v234
    v_permlane32_swap_b32 v233, v235
    buffer_store_dwordx4 v[232:235], v12, s[28:31], s77 offen offset:1024 sc1
    s_waitcnt lgkmcnt(0)
    v_mfma_f32_32x32x16_bf16 v[128:143], a[208:211], v[88:91], v[128:143]
    v_mfma_f32_32x32x16_bf16 v[160:175], a[212:215], v[88:91], v[160:175]
    s_waitcnt vmcnt(15)
    ds_read_b64_tr_b16 a[240:241], v6 offset:20480
    ds_read_b64_tr_b16 a[242:243], v6 offset:21504
    v_mfma_f32_32x32x16_bf16 v[144:159], a[208:211], v[120:123], v[144:159]
    ds_read_b64_tr_b16 a[244:245], v7 offset:20480
    ds_read_b64_tr_b16 a[246:247], v7 offset:21504
    v_mfma_f32_32x32x16_bf16 v[176:191], a[212:215], v[120:123], v[176:191]
    ds_read_b64_tr_b16 a[248:249], v6 offset:22528
    ds_read_b64_tr_b16 a[250:251], v6 offset:23552
    v_mfma_f32_32x32x16_bf16 v[128:143], a[216:219], v[92:95], v[128:143]
    ds_read_b64_tr_b16 a[252:253], v7 offset:22528
    ds_read_b64_tr_b16 a[254:255], v7 offset:23552
    v_cvt_pk_bf16_f32 v240, v240, v241
    v_cvt_pk_bf16_f32 v241, v242, v243
    v_mfma_f32_32x32x16_bf16 v[160:175], a[220:223], v[92:95], v[160:175]
    v_cvt_pk_bf16_f32 v242, v244, v245
    v_cvt_pk_bf16_f32 v243, v246, v247
    s_nop 0
    v_permlane32_swap_b32 v240, v242
    v_permlane32_swap_b32 v241, v243
    buffer_store_dwordx4 v[240:243], v12, s[28:31], s77 offen offset:2048 sc1
    v_mfma_f32_32x32x16_bf16 v[144:159], a[216:219], v[124:127], v[144:159]
    v_cvt_pk_bf16_f32 v248, v248, v249
    v_cvt_pk_bf16_f32 v249, v250, v251
    v_mfma_f32_32x32x16_bf16 v[176:191], a[220:223], v[124:127], v[176:191]
    v_cvt_pk_bf16_f32 v250, v252, v253
    v_cvt_pk_bf16_f32 v251, v254, v255
    s_nop 0
    v_permlane32_swap_b32 v248, v250
    v_permlane32_swap_b32 v249, v251
    buffer_store_dwordx4 v[248:251], v12, s[28:31], s77 offen offset:3072 sc1
    s_waitcnt lgkmcnt(0)
    v_mfma_f32_32x32x16_bf16 v[128:143], a[224:227], a[64:67], v[128:143]
    v_mfma_f32_32x32x16_bf16 v[160:175], a[228:231], a[64:67], v[160:175]
    s_waitcnt vmcnt(13)
    ds_read_b64_tr_b16 a[192:193], v6 offset:0
    ds_read_b64_tr_b16 a[194:195], v6 offset:1024
    v_mfma_f32_32x32x16_bf16 v[144:159], a[224:227], a[96:99], v[144:159]
    ds_read_b64_tr_b16 a[196:197], v7 offset:0
    ds_read_b64_tr_b16 a[198:199], v7 offset:1024
    v_mfma_f32_32x32x16_bf16 v[176:191], a[228:231], a[96:99], v[176:191]
    ds_read_b64_tr_b16 a[200:201], v6 offset:2048
    ds_read_b64_tr_b16 a[202:203], v6 offset:3072
    s_waitcnt vmcnt(4)
    v_readfirstlane_b32 s52, v16
    s_or_b32 s52, s52, s53
    s_and_b32 s52, s52, 0xff
    s_cmp_lg_u32 s52, 0xff
    s_cbranch_scc1 L_noearly
    s_lshl_b32 s48, s72, 9
    s_add_u32 s48, s48, s45
    buffer_load_dwordx4 v[32:35], v19, s[28:31], s48 offen sc1
    s_add_u32 s48, s48, 8192
    buffer_load_dwordx4 v[36:39], v19, s[28:31], s48 offen sc1
    s_add_u32 s48, s48, 8192
    buffer_load_dwordx4 v[40:43], v19, s[28:31], s48 offen sc1
    s_add_u32 s48, s48, 8192
    buffer_load_dwordx4 v[44:47], v19, s[28:31], s48 offen sc1
    s_add_u32 s48, s48, 8192
    buffer_load_dwordx4 v[48:51], v19, s[28:31], s48 offen sc1
    s_add_u32 s48, s48, 8192
    buffer_load_dwordx4 v[52:55], v19, s[28:31], s48 offen sc1
    s_add_u32 s48, s48, 8192
    buffer_load_dwordx4 v[56:59], v19, s[28:31], s48 offen sc1
    s_add_u32 s48, s48, 8192
    buffer_load_dwordx4 v[60:63], v19, s[28:31], s48 offen sc1
    s_mov_b32 s54, 1
L_noearly:
    v_mfma_f32_32x32x16_bf16 v[128:143], a[232:235], a[68:71], v[128:143]
    ds_read_b64_tr_b16 a[204:205], v7 offset:2048
    ds_read_b64_tr_b16 a[206:207], v7 offset:3072
    v_mfma_f32_32x32x16_bf16 v[160:175], a[236:239], a[68:71], v[160:175]
    v_mfma_f32_32x32x16_bf16 v[144:159], a[232:235], a[100:103], v[144:159]
    v_mfma_f32_32x32x16_bf16 v[176:191], a[236:239], a[100:103], v[176:191]
    s_waitcnt lgkmcnt(0)
    v_mfma_f32_32x32x16_bf16 v[128:143], a[240:243], a[72:75], v[128:143]
    v_mfma_f32_32x32x16_bf16 v[160:175], a[244:247], a[72:75], v[160:175]
    ds_read_b64_tr_b16 a[208:209], v6 offset:4096
    ds_read_b64_tr_b16 a[210:211], v6 offset:5120
    v_mfma_f32_32x32x16_bf16 v[144:159], a[240:243], a[104:107], v[144:159]
    ds_read_b64_tr_b16 a[212:213], v7 offset:4096
    ds_read_b64_tr_b16 a[214:215], v7 offset:5120
    v_mfma_f32_32x32x16_bf16 v[176:191], a[244:247], a[104:107], v[176:191]
    ds_read_b64_tr_b16 a[216:217], v6 offset:6144
    ds_read_b64_tr_b16 a[218:219], v6 offset:7168
    v_mfma_f32_32x32x16_bf16 v[128:143], a[248:251], a[76:79], v[128:143]
    ds_read_b64_tr_b16 a[220:221], v7 offset:6144
    ds_read_b64_tr_b16 a[222:223], v7 offset:7168
    v_mfma_f32_32x32x16_bf16 v[160:175], a[252:255], a[76:79], v[160:175]
    v_mfma_f32_32x32x16_bf16 v[144:159], a[248:251], a[108:111], v[144:159]
    v_mfma_f32_32x32x16_bf16 v[176:191], a[252:255], a[108:111], v[176:191]
    s_waitcnt lgkmcnt(0)
    v_mfma_f32_32x32x16_bf16 v[128:143], a[192:195], a[80:83], v[128:143]
    v_mfma_f32_32x32x16_bf16 v[160:175], a[196:199], a[80:83], v[160:175]
    v_mfma_f32_32x32x16_bf16 v[144:159], a[192:195], a[112:115], v[144:159]
    v_mfma_f32_32x32x16_bf16 v[176:191], a[196:199], a[112:115], v[176:191]
    v_mfma_f32_32x32x16_bf16 v[128:143], a[200:203], a[84:87], v[128:143]
    v_mfma_f32_32x32x16_bf16 v[160:175], a[204:207], a[84:87], v[160:175]
    v_mfma_f32_32x32x16_bf16 v[144:159], a[200:203], a[116:119], v[144:159]
    v_mfma_f32_32x32x16_bf16 v[176:191], a[204:207], a[116:119], v[176:191]
    v_mfma_f32_32x32x16_bf16 v[128:143], a[208:211], a[88:91], v[128:143]
    v_mfma_f32_32x32x16_bf16 v[160:175], a[212:215], a[88:91], v[160:175]
    v_mfma_f32_32x32x16_bf16 v[144:159], a[208:211], a[120:123], v[144:159]
    v_mfma_f32_32x32x16_bf16 v[176:191], a[212:215], a[120:123], v[176:191]
    v_mfma_f32_32x32x16_bf16 v[128:143], a[216:219], a[92:95], v[128:143]
    v_mfma_f32_32x32x16_bf16 v[160:175], a[220:223], a[92:95], v[160:175]
    v_mfma_f32_32x32x16_bf16 v[144:159], a[216:219], a[124:127], v[144:159]
    v_mfma_f32_32x32x16_bf16 v[176:191], a[220:223], a[124:127], v[176:191]
    s_cmp_eq_u32 s54, 0
    s_cbranch_scc1 L_w0
    s_waitcnt vmcnt(8)
    s_branch L_w1
L_w0:
    s_waitcnt vmcnt(0)
L_w1:
    v_lshlrev_b32 v17, 8, v17
    buffer_atomic_or v17, v14, s[28:31], s50 offen offset:0 sc1
    v_lshlrev_b32 v9, 4, v0
    v_add_u32 v8, s64, v9
    s_xor_b32 s79, s32, 1
    s_mul_i32 s79, s79, 24576
    v_add_u32 v9, s79, v9
    s_add_u32 s3, s78, 4096
    s_bitcmp1_b32 s32, 0
    s_cbranch_scc1 L_odd
    ds_write_b128 v8, v[144:147] offset:0
    ds_write_b128 v8, v[148:151] offset:1024
    ds_write_b128 v8, v[152:155] offset:2048
    ds_write_b128 v8, v[156:159] offset:3072
    ds_write_b128 v8, v[176:179] offset:4096
    ds_write_b128 v8, v[180:183] offset:5120
    ds_write_b128 v8, v[184:187] offset:6144
    ds_write_b128 v8, v[188:191] offset:7168
    s_waitcnt lgkmcnt(0)
    s_barrier
    ds_read_b128 v[192:195], v9 offset:0
    ds_read_b128 v[196:199], v9 offset:1024
    ds_read_b128 v[200:203], v9 offset:2048
    ds_read_b128 v[204:207], v9 offset:3072
    ds_read_b128 v[208:211], v9 offset:4096
    ds_read_b128 v[212:215], v9 offset:5120
    ds_read_b128 v[216:219], v9 offset:6144
    ds_read_b128 v[220:223], v9 offset:7168
    s_waitcnt lgkmcnt(6)
    v_add_f32 v128, v128, v192
    v_add_f32 v129, v129, v193
    v_add_f32 v130, v130, v194
    v_add_f32 v131, v131, v195
    v_add_f32 v132, v132, v196
    v_add_f32 v133, v133, v197
    v_add_f32 v134, v134, v198
    v_add_f32 v135, v135, v199
    v_cvt_pk_bf16_f32 v128, v128, v129
    v_cvt_pk_bf16_f32 v129, v130, v131
    v_cvt_pk_bf16_f32 v130, v132, v133
    v_cvt_pk_bf16_f32 v131, v134, v135
    s_nop 0
    v_permlane32_swap_b32 v128, v130
    v_permlane32_swap_b32 v129, v131
    buffer_store_dwordx4 v[128:131], v12, s[28:31], s78 offen offset:0 sc1
    s_waitcnt lgkmcnt(4)
    v_add_f32 v136, v136, v200
    v_add_f32 v137, v137, v201
    v_add_f32 v138, v138, v202
    v_add_f32 v139, v139, v203
    v_add_f32 v140, v140, v204
    v_add_f32 v141, v141, v205
    v_add_f32 v142, v142, v206
    v_add_f32 v143, v143, v207
    v_cvt_pk_bf16_f32 v136, v136, v137
    v_cvt_pk_bf16_f32 v137, v138, v139
    v_cvt_pk_bf16_f32 v138, v140, v141
    v_cvt_pk_bf16_f32 v139, v142, v143
    s_nop 0
    v_permlane32_swap_b32 v136, v138
    v_permlane32_swap_b32 v137, v139
    buffer_store_dwordx4 v[136:139], v12, s[28:31], s78 offen offset:1024 sc1
    s_waitcnt lgkmcnt(2)
    v_add_f32 v160, v160, v208
    v_add_f32 v161, v161, v209
    v_add_f32 v162, v162, v210
    v_add_f32 v163, v163, v211
    v_add_f32 v164, v164, v212
    v_add_f32 v165, v165, v213
    v_add_f32 v166, v166, v214
    v_add_f32 v167, v167, v215
    v_cvt_pk_bf16_f32 v160, v160, v161
    v_cvt_pk_bf16_f32 v161, v162, v163
    v_cvt_pk_bf16_f32 v162, v164, v165
    v_cvt_pk_bf16_f32 v163, v166, v167
    s_nop 0
    v_permlane32_swap_b32 v160, v162
    v_permlane32_swap_b32 v161, v163
    buffer_store_dwordx4 v[160:163], v12, s[28:31], s3 offen offset:0 sc1
    s_waitcnt lgkmcnt(0)
    v_add_f32 v168, v168, v216
    v_add_f32 v169, v169, v217
    v_add_f32 v170, v170, v218
    v_add_f32 v171, v171, v219
    v_add_f32 v172, v172, v220
    v_add_f32 v173, v173, v221
    v_add_f32 v174, v174, v222
    v_add_f32 v175, v175, v223
    v_cvt_pk_bf16_f32 v168, v168, v169
    v_cvt_pk_bf16_f32 v169, v170, v171
    v_cvt_pk_bf16_f32 v170, v172, v173
    v_cvt_pk_bf16_f32 v171, v174, v175
    s_nop 0
    v_permlane32_swap_b32 v168, v170
    v_permlane32_swap_b32 v169, v171
    buffer_store_dwordx4 v[168:171], v12, s[28:31], s3 offen offset:1024 sc1
    s_branch L_fin
L_odd:
    ds_write_b128 v8, v[128:131] offset:0
    ds_write_b128 v8, v[132:135] offset:1024
    ds_write_b128 v8, v[136:139] offset:2048
    ds_write_b128 v8, v[140:143] offset:3072
    ds_write_b128 v8, v[160:163] offset:4096
    ds_write_b128 v8, v[164:167] offset:5120
    ds_write_b128 v8, v[168:171] offset:6144
    ds_write_b128 v8, v[172:175] offset:7168
    s_waitcnt lgkmcnt(0)
    s_barrier
    ds_read_b128 v[192:195], v9 offset:0
    ds_read_b128 v[196:199], v9 offset:1024
    ds_read_b128 v[200:203], v9 offset:2048
    ds_read_b128 v[204:207], v9 offset:3072
    ds_read_b128 v[208:211], v9 offset:4096
    ds_read_b128 v[212:215], v9 offset:5120
    ds_read_b128 v[216:219], v9 offset:6144
    ds_read_b128 v[220:223], v9 offset:7168
    s_waitcnt lgkmcnt(6)
    v_add_f32 v144, v144, v192
    v_add_f32 v145, v145, v193
    v_add_f32 v146, v146, v194
    v_add_f32 v147, v147, v195
    v_add_f32 v148, v148, v196
    v_add_f32 v149, v149, v197
    v_add_f32 v150, v150, v198
    v_add_f32 v151, v151, v199
    v_cvt_pk_bf16_f32 v144, v144, v145
    v_cvt_pk_bf16_f32 v145, v146, v147
    v_cvt_pk_bf16_f32 v146, v148, v149
    v_cvt_pk_bf16_f32 v147, v150, v151
    s_nop 0
    v_permlane32_swap_b32 v144, v146
    v_permlane32_swap_b32 v145, v147
    buffer_store_dwordx4 v[144:147], v12, s[28:31], s78 offen offset:2048 sc1
    s_waitcnt lgkmcnt(4)
    v_add_f32 v152, v152, v200
    v_add_f32 v153, v153, v201
    v_add_f32 v154, v154, v202
    v_add_f32 v155, v155, v203
    v_add_f32 v156, v156, v204
    v_add_f32 v157, v157, v205
    v_add_f32 v158, v158, v206
    v_add_f32 v159, v159, v207
    v_cvt_pk_bf16_f32 v152, v152, v153
    v_cvt_pk_bf16_f32 v153, v154, v155
    v_cvt_pk_bf16_f32 v154, v156, v157
    v_cvt_pk_bf16_f32 v155, v158, v159
    s_nop 0
    v_permlane32_swap_b32 v152, v154
    v_permlane32_swap_b32 v153, v155
    buffer_store_dwordx4 v[152:155], v12, s[28:31], s78 offen offset:3072 sc1
    s_waitcnt lgkmcnt(2)
    v_add_f32 v176, v176, v208
    v_add_f32 v177, v177, v209
    v_add_f32 v178, v178, v210
    v_add_f32 v179, v179, v211
    v_add_f32 v180, v180, v212
    v_add_f32 v181, v181, v213
    v_add_f32 v182, v182, v214
    v_add_f32 v183, v183, v215
    v_cvt_pk_bf16_f32 v176, v176, v177
    v_cvt_pk_bf16_f32 v177, v178, v179
    v_cvt_pk_bf16_f32 v178, v180, v181
    v_cvt_pk_bf16_f32 v179, v182, v183
    s_nop 0
    v_permlane32_swap_b32 v176, v178
    v_permlane32_swap_b32 v177, v179
    buffer_store_dwordx4 v[176:179], v12, s[28:31], s3 offen offset:2048 sc1
    s_waitcnt lgkmcnt(0)
    v_add_f32 v184, v184, v216
    v_add_f32 v185, v185, v217
    v_add_f32 v186, v186, v218
    v_add_f32 v187, v187, v219
    v_add_f32 v188, v188, v220
    v_add_f32 v189, v189, v221
    v_add_f32 v190, v190, v222
    v_add_f32 v191, v191, v223
    v_cvt_pk_bf16_f32 v184, v184, v185
    v_cvt_pk_bf16_f32 v185, v186, v187
    v_cvt_pk_bf16_f32 v186, v188, v189
    v_cvt_pk_bf16_f32 v187, v190, v191
    s_nop 0
    v_permlane32_swap_b32 v184, v186
    v_permlane32_swap_b32 v185, v187
    buffer_store_dwordx4 v[184:187], v12, s[28:31], s3 offen offset:3072 sc1
L_fin:
    v_mov_b32 v16, 0
    buffer_atomic_or v16, v18, s[28:31], s51 offen sc0 sc1
    v_mov_b32 v6, 268435456
    v_cmp_eq_u32 vcc, 0, v0
    s_nop 1
    v_cndmask_b32 v6, v6, 0, vcc
    v_mov_b32 v2, 0
    v_mov_b32 v3, 1
    s_cmp_eq_u32 s54, 0
    s_cbranch_scc1 L_t0
    s_waitcnt vmcnt(13)
    v_mfma_f32_32x32x16_bf16 v[96:111], v[24:27], v[32:35], 0
    s_waitcnt vmcnt(12)
    v_mfma_f32_32x32x16_bf16 v[96:111], v[24:27], v[36:39], v[96:111]
    s_waitcnt vmcnt(11)
    v_mfma_f32_32x32x16_bf16 v[96:111], v[24:27], v[40:43], v[96:111]
    s_waitcnt vmcnt(10)
    v_mfma_f32_32x32x16_bf16 v[96:111], v[24:27], v[44:47], v[96:111]
    s_waitcnt vmcnt(9)
    v_mfma_f32_32x32x16_bf16 v[96:111], v[24:27], v[48:51], v[96:111]
    s_waitcnt vmcnt(8)
    v_mfma_f32_32x32x16_bf16 v[96:111], v[24:27], v[52:55], v[96:111]
    s_waitcnt vmcnt(7)
    v_mfma_f32_32x32x16_bf16 v[96:111], v[24:27], v[56:59], v[96:111]
    s_waitcnt vmcnt(6)
    v_mfma_f32_32x32x16_bf16 v[96:111], v[24:27], v[60:63], v[96:111]
    s_nop 11
    v_cvt_pk_bf16_f32 v28, v96, v97
    v_cvt_pk_bf16_f32 v29, v98, v99
    v_cvt_pk_bf16_f32 v30, v100, v101
    v_cvt_pk_bf16_f32 v31, v102, v103
    s_nop 0
    v_permlane32_swap_b32 v28, v30
    v_permlane32_swap_b32 v29, v31
    s_add_u32 s48, s42, s72
    buffer_store_dwordx4 v[28:31], v13, s[12:15], s48 offen sc1
    s_waitcnt vmcnt(1)
    s_branch L_t1
L_t0:
    s_waitcnt vmcnt(0)
L_t1:
    v_lshlrev_b32 v17, 8, v17
    buffer_atomic_or v17, v15, s[28:31], s47 offen offset:0 sc1
    s_barrier
L_spa:
    v_readfirstlane_b32 s52, v16
    s_or_b32 s52, s52, s53
    s_andn2_b32 s52, 0xffff, s52
    s_cbranch_scc0 L_oka
    s_sub_u32 s55, s55, 1
    s_cbranch_scc1 L_toa
    v_mov_b32 v16, 0
    buffer_atomic_or v16, v18, s[28:31], s51 offen sc0 sc1
    s_waitcnt vmcnt(0)
    s_branch L_spa
L_toa:
    s_lshl_b32 s52, s34, 2
    s_add_u32 s52, s52, s32
    s_lshl_b32 s52, 1, s52
    v_mov_b32 v4, s52
    v_mov_b32 v5, 0
    buffer_atomic_add_x2 v[4:5], v6, s[16:19], s43 offen sc0 sc1
    s_waitcnt vmcnt(0)
    v_readfirstlane_b32 s52, v5
    s_cmp_lg_u32 s52, 8
    s_cbranch_scc1 L_drop
    s_mov_b32 s53, -1
L_oka:
    s_cmp_lg_u32 s54, 0
    s_cbranch_scc1 L_t3
    s_lshl_b32 s48, s72, 9
    s_add_u32 s48, s48, s45
    buffer_load_dwordx4 v[32:35], v19, s[28:31], s48 offen sc1
    s_add_u32 s48, s48, 8192
    buffer_load_dwordx4 v[36:39], v19, s[28:31], s48 offen sc1
    s_add_u32 s48, s48, 8192
    buffer_load_dwordx4 v[40:43], v19, s[28:31], s48 offen sc1
    s_add_u32 s48, s48, 8192
    buffer_load_dwordx4 v[44:47], v19, s[28:31], s48 offen sc1
    s_add_u32 s48, s48, 8192
    buffer_load_dwordx4 v[48:51], v19, s[28:31], s48 offen sc1
    s_add_u32 s48, s48, 8192
    buffer_load_dwordx4 v[52:55], v19, s[28:31], s48 offen sc1
    s_add_u32 s48, s48, 8192
    buffer_load_dwordx4 v[56:59], v19, s[28:31], s48 offen sc1
    s_add_u32 s48, s48, 8192
    buffer_load_dwordx4 v[60:63], v19, s[28:31], s48 offen sc1
L_t3:
    s_lshl_b32 s48, s73, 9
    s_add_u32 s48, s48, s45
    buffer_load_dwordx4 v[224:227], v19, s[28:31], s48 offen sc1
    s_add_u32 s48, s48, 8192
    buffer_load_dwordx4 v[228:231], v19, s[28:31], s48 offen sc1
    s_add_u32 s48, s48, 8192
    buffer_load_dwordx4 v[232:235], v19, s[28:31], s48 offen sc1
    s_add_u32 s48, s48, 8192
    buffer_load_dwordx4 v[236:239], v19, s[28:31], s48 offen sc1
    s_add_u32 s48, s48, 8192
    buffer_load_dwordx4 v[240:243], v19, s[28:31], s48 offen sc1
    s_add_u32 s48, s48, 8192
    buffer_load_dwordx4 v[244:247], v19, s[28:31], s48 offen sc1
    s_add_u32 s48, s48, 8192
    buffer_load_dwordx4 v[248:251], v19, s[28:31], s48 offen sc1
    s_add_u32 s48, s48, 8192
    buffer_load_dwordx4 v[252:255], v19, s[28:31], s48 offen sc1
    s_bitcmp1_b32 s32, 0
    s_cbranch_scc0 L_even
    s_cmp_lg_u32 s54, 0
    s_cbranch_scc1 L_t4
    s_waitcnt vmcnt(15)
    v_mfma_f32_32x32x16_bf16 v[96:111], v[24:27], v[32:35], 0
    s_waitcnt vmcnt(14)
    v_mfma_f32_32x32x16_bf16 v[96:111], v[24:27], v[36:39], v[96:111]
    s_waitcnt vmcnt(13)
    v_mfma_f32_32x32x16_bf16 v[96:111], v[24:27], v[40:43], v[96:111]
    s_waitcnt vmcnt(12)
    v_mfma_f32_32x32x16_bf16 v[96:111], v[24:27], v[44:47], v[96:111]
    s_waitcnt vmcnt(11)
    v_mfma_f32_32x32x16_bf16 v[96:111], v[24:27], v[48:51], v[96:111]
    s_waitcnt vmcnt(10)
    v_mfma_f32_32x32x16_bf16 v[96:111], v[24:27], v[52:55], v[96:111]
    s_waitcnt vmcnt(9)
    v_mfma_f32_32x32x16_bf16 v[96:111], v[24:27], v[56:59], v[96:111]
    s_waitcnt vmcnt(8)
    v_mfma_f32_32x32x16_bf16 v[96:111], v[24:27], v[60:63], v[96:111]
    s_nop 11
    v_cvt_pk_bf16_f32 v28, v96, v97
    v_cvt_pk_bf16_f32 v29, v98, v99
    v_cvt_pk_bf16_f32 v30, v100, v101
    v_cvt_pk_bf16_f32 v31, v102, v103
    s_nop 0
    v_permlane32_swap_b32 v28, v30
    v_permlane32_swap_b32 v29, v31
    s_add_u32 s48, s42, s72
    buffer_store_dwordx4 v[28:31], v13, s[12:15], s48 offen sc1
    s_waitcnt vmcnt(8)
    v_mfma_f32_32x32x16_bf16 v[112:127], v[24:27], v[224:227], 0
    s_waitcnt vmcnt(7)
    v_mfma_f32_32x32x16_bf16 v[112:127], v[24:27], v[228:231], v[112:127]
    s_waitcnt vmcnt(6)
    v_mfma_f32_32x32x16_bf16 v[112:127], v[24:27], v[232:235], v[112:127]
    s_waitcnt vmcnt(5)
    v_mfma_f32_32x32x16_bf16 v[112:127], v[24:27], v[236:239], v[112:127]
    s_waitcnt vmcnt(4)
    v_mfma_f32_32x32x16_bf16 v[112:127], v[24:27], v[240:243], v[112:127]
    s_waitcnt vmcnt(3)
    v_mfma_f32_32x32x16_bf16 v[112:127], v[24:27], v[244:247], v[112:127]
    s_waitcnt vmcnt(2)
    v_mfma_f32_32x32x16_bf16 v[112:127], v[24:27], v[248:251], v[112:127]
    s_waitcnt vmcnt(1)
    v_mfma_f32_32x32x16_bf16 v[112:127], v[24:27], v[252:255], v[112:127]
    s_nop 11
    v_cvt_pk_bf16_f32 v8, v112, v113
    v_cvt_pk_bf16_f32 v9, v114, v115
    v_cvt_pk_bf16_f32 v10, v116, v117
    v_cvt_pk_bf16_f32 v11, v118, v119
    s_nop 0
    v_permlane32_swap_b32 v8, v10
    v_permlane32_swap_b32 v9, v11
    s_add_u32 s48, s42, s73
    buffer_store_dwordx4 v[8:11], v13, s[12:15], s48 offen sc1
    s_branch L_drop
L_t4:
    s_waitcnt vmcnt(7)
    v_mfma_f32_32x32x16_bf16 v[96:111], v[24:27], v[224:227], 0
    s_waitcnt vmcnt(6)
    v_mfma_f32_32x32x16_bf16 v[96:111], v[24:27], v[228:231], v[96:111]
    s_waitcnt vmcnt(5)
    v_mfma_f32_32x32x16_bf16 v[96:111], v[24:27], v[232:235], v[96:111]
    s_waitcnt vmcnt(4)
    v_mfma_f32_32x32x16_bf16 v[96:111], v[24:27], v[236:239], v[96:111]
    s_waitcnt vmcnt(3)
    v_mfma_f32_32x32x16_bf16 v[96:111], v[24:27], v[240:243], v[96:111]
    s_waitcnt vmcnt(2)
    v_mfma_f32_32x32x16_bf16 v[96:111], v[24:27], v[244:247], v[96:111]
    s_waitcnt vmcnt(1)
    v_mfma_f32_32x32x16_bf16 v[96:111], v[24:27], v[248:251], v[96:111]
    s_waitcnt vmcnt(0)
    v_mfma_f32_32x32x16_bf16 v[96:111], v[24:27], v[252:255], v[96:111]
    s_nop 11
    v_cvt_pk_bf16_f32 v28, v96, v97
    v_cvt_pk_bf16_f32 v29, v98, v99
    v_cvt_pk_bf16_f32 v30, v100, v101
    v_cvt_pk_bf16_f32 v31, v102, v103
    s_nop 0
    v_permlane32_swap_b32 v28, v30
    v_permlane32_swap_b32 v29, v31
    s_add_u32 s48, s42, s73
    buffer_store_dwordx4 v[28:31], v13, s[12:15], s48 offen sc1
    s_branch L_drop
L_even:
L_spb:
    v_readfirstlane_b32 s52, v16
    s_or_b32 s52, s52, s53
    s_andn2_b32 s52, 0xffffff, s52
    s_cbranch_scc0 L_okb
    s_sub_u32 s55, s55, 1
    s_cbranch_scc1 L_tob
    v_mov_b32 v16, 0
    buffer_atomic_or v16, v18, s[28:31], s51 offen sc0 sc1
    s_waitcnt vmcnt(0)
    s_branch L_spb
L_tob:
    s_lshl_b32 s52, s34, 2
    s_add_u32 s52, s52, s32
    s_lshl_b32 s52, 1, s52
    v_mov_b32 v4, s52
    v_mov_b32 v5, 0
    buffer_atomic_add_x2 v[4:5], v6, s[16:19], s43 offen sc0 sc1
    s_waitcnt vmcnt(0)
    v_readfirstlane_b32 s52, v5
    s_cmp_lg_u32 s52, 8
    s_cbranch_scc1 L_drop
    s_mov_b32 s53, -1
L_okb:
    s_lshl_b32 s48, s74, 9
    s_add_u32 s48, s48, s45
    buffer_load_dwordx4 v[64:67], v19, s[28:31], s48 offen sc1
    s_add_u32 s48, s48, 8192
    buffer_load_dwordx4 v[68:71], v19, s[28:31], s48 offen sc1
    s_add_u32 s48, s48, 8192
    buffer_load_dwordx4 v[72:75], v19, s[28:31], s48 offen sc1
    s_add_u32 s48, s48, 8192
    buffer_load_dwordx4 v[76:79], v19, s[28:31], s48 offen sc1
    s_add_u32 s48, s48, 8192
    buffer_load_dwordx4 v[80:83], v19, s[28:31], s48 offen sc1
    s_add_u32 s48, s48, 8192
    buffer_load_dwordx4 v[84:87], v19, s[28:31], s48 offen sc1
    s_add_u32 s48, s48, 8192
    buffer_load_dwordx4 v[88:91], v19, s[28:31], s48 offen sc1
    s_add_u32 s48, s48, 8192
    buffer_load_dwordx4 v[92:95], v19, s[28:31], s48 offen sc1
    s_cmp_lg_u32 s54, 0
    s_cbranch_scc1 L_t5
    s_waitcnt vmcnt(23)
    v_mfma_f32_32x32x16_bf16 v[112:127], v[24:27], v[32:35], 0
    s_waitcnt vmcnt(22)
    v_mfma_f32_32x32x16_bf16 v[112:127], v[24:27], v[36:39], v[112:127]
    s_waitcnt vmcnt(21)
    v_mfma_f32_32x32x16_bf16 v[112:127], v[24:27], v[40:43], v[112:127]
    s_waitcnt vmcnt(20)
    v_mfma_f32_32x32x16_bf16 v[112:127], v[24:27], v[44:47], v[112:127]
    s_waitcnt vmcnt(19)
    v_mfma_f32_32x32x16_bf16 v[112:127], v[24:27], v[48:51], v[112:127]
    s_waitcnt vmcnt(18)
    v_mfma_f32_32x32x16_bf16 v[112:127], v[24:27], v[52:55], v[112:127]
    s_waitcnt vmcnt(17)
    v_mfma_f32_32x32x16_bf16 v[112:127], v[24:27], v[56:59], v[112:127]
    s_waitcnt vmcnt(16)
    v_mfma_f32_32x32x16_bf16 v[112:127], v[24:27], v[60:63], v[112:127]
    s_nop 11
    v_cvt_pk_bf16_f32 v8, v112, v113
    v_cvt_pk_bf16_f32 v9, v114, v115
    v_cvt_pk_bf16_f32 v10, v116, v117
    v_cvt_pk_bf16_f32 v11, v118, v119
    s_nop 0
    v_permlane32_swap_b32 v8, v10
    v_permlane32_swap_b32 v9, v11
    s_add_u32 s48, s42, s72
    buffer_store_dwordx4 v[8:11], v13, s[12:15], s48 offen sc1
    s_waitcnt vmcnt(16)
    v_mfma_f32_32x32x16_bf16 v[96:111], v[24:27], v[224:227], 0
    s_waitcnt vmcnt(15)
    v_mfma_f32_32x32x16_bf16 v[96:111], v[24:27], v[228:231], v[96:111]
    s_waitcnt vmcnt(14)
    v_mfma_f32_32x32x16_bf16 v[96:111], v[24:27], v[232:235], v[96:111]
    s_waitcnt vmcnt(13)
    v_mfma_f32_32x32x16_bf16 v[96:111], v[24:27], v[236:239], v[96:111]
    s_waitcnt vmcnt(12)
    v_mfma_f32_32x32x16_bf16 v[96:111], v[24:27], v[240:243], v[96:111]
    s_waitcnt vmcnt(11)
    v_mfma_f32_32x32x16_bf16 v[96:111], v[24:27], v[244:247], v[96:111]
    s_waitcnt vmcnt(10)
    v_mfma_f32_32x32x16_bf16 v[96:111], v[24:27], v[248:251], v[96:111]
    s_waitcnt vmcnt(9)
    v_mfma_f32_32x32x16_bf16 v[96:111], v[24:27], v[252:255], v[96:111]
    s_nop 11
    v_cvt_pk_bf16_f32 v28, v96, v97
    v_cvt_pk_bf16_f32 v29, v98, v99
    v_cvt_pk_bf16_f32 v30, v100, v101
    v_cvt_pk_bf16_f32 v31, v102, v103
    s_nop 0
    v_permlane32_swap_b32 v28, v30
    v_permlane32_swap_b32 v29, v31
    s_add_u32 s48, s42, s73
    buffer_store_dwordx4 v[28:31], v13, s[12:15], s48 offen sc1
    s_waitcnt vmcnt(9)
    v_mfma_f32_32x32x16_bf16 v[112:127], v[24:27], v[64:67], 0
    s_waitcnt vmcnt(8)
    v_mfma_f32_32x32x16_bf16 v[112:127], v[24:27], v[68:71], v[112:127]
    s_waitcnt vmcnt(7)
    v_mfma_f32_32x32x16_bf16 v[112:127], v[24:27], v[72:75], v[112:127]
    s_waitcnt vmcnt(6)
    v_mfma_f32_32x32x16_bf16 v[112:127], v[24:27], v[76:79], v[112:127]
    s_waitcnt vmcnt(5)
    v_mfma_f32_32x32x16_bf16 v[112:127], v[24:27], v[80:83], v[112:127]
    s_waitcnt vmcnt(4)
    v_mfma_f32_32x32x16_bf16 v[112:127], v[24:27], v[84:87], v[112:127]
    s_waitcnt vmcnt(3)
    v_mfma_f32_32x32x16_bf16 v[112:127], v[24:27], v[88:91], v[112:127]
    s_waitcnt vmcnt(2)
    v_mfma_f32_32x32x16_bf16 v[112:127], v[24:27], v[92:95], v[112:127]
    s_nop 11
    v_cvt_pk_bf16_f32 v8, v112, v113
    v_cvt_pk_bf16_f32 v9, v114, v115
    v_cvt_pk_bf16_f32 v10, v116, v117
    v_cvt_pk_bf16_f32 v11, v118, v119
    s_nop 0
    v_permlane32_swap_b32 v8, v10
    v_permlane32_swap_b32 v9, v11
    s_add_u32 s48, s42, s74
    buffer_store_dwordx4 v[8:11], v13, s[12:15], s48 offen sc1
    s_branch L_drop
L_t5:
    s_waitcnt vmcnt(15)
    v_mfma_f32_32x32x16_bf16 v[96:111], v[24:27], v[224:227], 0
    s_waitcnt vmcnt(14)
    v_mfma_f32_32x32x16_bf16 v[96:111], v[24:27], v[228:231], v[96:111]
    s_waitcnt vmcnt(13)
    v_mfma_f32_32x32x16_bf16 v[96:111], v[24:27], v[232:235], v[96:111]
    s_waitcnt vmcnt(12)
    v_mfma_f32_32x32x16_bf16 v[96:111], v[24:27], v[236:239], v[96:111]
    s_waitcnt vmcnt(11)
    v_mfma_f32_32x32x16_bf16 v[96:111], v[24:27], v[240:243], v[96:111]
    s_waitcnt vmcnt(10)
    v_mfma_f32_32x32x16_bf16 v[96:111], v[24:27], v[244:247], v[96:111]
    s_waitcnt vmcnt(9)
    v_mfma_f32_32x32x16_bf16 v[96:111], v[24:27], v[248:251], v[96:111]
    s_waitcnt vmcnt(8)
    v_mfma_f32_32x32x16_bf16 v[96:111], v[24:27], v[252:255], v[96:111]
    s_nop 11
    v_cvt_pk_bf16_f32 v28, v96, v97
    v_cvt_pk_bf16_f32 v29, v98, v99
    v_cvt_pk_bf16_f32 v30, v100, v101
    v_cvt_pk_bf16_f32 v31, v102, v103
    s_nop 0
    v_permlane32_swap_b32 v28, v30
    v_permlane32_swap_b32 v29, v31
    s_add_u32 s48, s42, s73
    buffer_store_dwordx4 v[28:31], v13, s[12:15], s48 offen sc1
    s_waitcnt vmcnt(8)
    v_mfma_f32_32x32x16_bf16 v[112:127], v[24:27], v[64:67], 0
    s_waitcnt vmcnt(7)
    v_mfma_f32_32x32x16_bf16 v[112:127], v[24:27], v[68:71], v[112:127]
    s_waitcnt vmcnt(6)
    v_mfma_f32_32x32x16_bf16 v[112:127], v[24:27], v[72:75], v[112:127]
    s_waitcnt vmcnt(5)
    v_mfma_f32_32x32x16_bf16 v[112:127], v[24:27], v[76:79], v[112:127]
    s_waitcnt vmcnt(4)
    v_mfma_f32_32x32x16_bf16 v[112:127], v[24:27], v[80:83], v[112:127]
    s_waitcnt vmcnt(3)
    v_mfma_f32_32x32x16_bf16 v[112:127], v[24:27], v[84:87], v[112:127]
    s_waitcnt vmcnt(2)
    v_mfma_f32_32x32x16_bf16 v[112:127], v[24:27], v[88:91], v[112:127]
    s_waitcnt vmcnt(1)
    v_mfma_f32_32x32x16_bf16 v[112:127], v[24:27], v[92:95], v[112:127]
    s_nop 11
    v_cvt_pk_bf16_f32 v8, v112, v113
    v_cvt_pk_bf16_f32 v9, v114, v115
    v_cvt_pk_bf16_f32 v10, v116, v117
    v_cvt_pk_bf16_f32 v11, v118, v119
    s_nop 0
    v_permlane32_swap_b32 v8, v10
    v_permlane32_swap_b32 v9, v11
    s_add_u32 s48, s42, s74
    buffer_store_dwordx4 v[8:11], v13, s[12:15], s48 offen sc1
L_drop:
    s_cmp_lg_u32 s32, 1
    s_cbranch_scc1 L_done
    buffer_atomic_add_x2 v[2:3], v6, s[16:19], s43 offen sc0 sc1
    s_waitcnt vmcnt(0)
    v_readfirstlane_b32 s56, v2
    v_readfirstlane_b32 s57, v3
    s_cmp_lg_u32 s57, 7
    s_cbranch_scc1 L_done
L_fb:
    s_cmp_eq_u32 s56, 0
    s_cbranch_scc1 L_done
    s_ff1_i32_b32 s58, s56
    s_bitset0_b32 s56, s58
    s_lshr_b32 s59, s58, 2
    s_and_b32 s58, s58, 3
    s_lshr_b32 s40, s59, 2
    s_and_b32 s41, s59, 3
    s_lshl_b32 s40, s40, 11
    s_lshl_b32 s41, s41, 7
    s_add_u32 s40, s40, s41
    s_mul_i32 s45, s44, 655360
    s_add_u32 s45, s45, s40
    s_mul_i32 s42, s35, 163840
    s_mul_i32 s43, s33, 1280
    s_add_u32 s42, s42, s43
    s_mul_i32 s43, s59, 20480
    s_add_u32 s42, s42, s43
    s_mov_b32 s60, s58
L_fb2:
    s_add_u32 s61, s60, s81
    s_sub_u32 s62, s61, 10
    s_cmp_ge_u32 s61, 10
    s_cselect_b32 s61, s62, s61
    s_lshl_b32 s61, s61, 7
    s_lshl_b32 s48, s61, 9
    s_add_u32 s48, s48, s45
    buffer_load_dwordx4 v[32:35], v19, s[28:31], s48 offen sc1
    s_add_u32 s48, s48, 8192
    buffer_load_dwordx4 v[36:39], v19, s[28:31], s48 offen sc1
    s_add_u32 s48, s48, 8192
    buffer_load_dwordx4 v[40:43], v19, s[28:31], s48 offen sc1
    s_add_u32 s48, s48, 8192
    buffer_load_dwordx4 v[44:47], v19, s[28:31], s48 offen sc1
    s_add_u32 s48, s48, 8192
    buffer_load_dwordx4 v[48:51], v19, s[28:31], s48 offen sc1
    s_add_u32 s48, s48, 8192
    buffer_load_dwordx4 v[52:55], v19, s[28:31], s48 offen sc1
    s_add_u32 s48, s48, 8192
    buffer_load_dwordx4 v[56:59], v19, s[28:31], s48 offen sc1
    s_add_u32 s48, s48, 8192
    buffer_load_dwordx4 v[60:63], v19, s[28:31], s48 offen sc1
    s_waitcnt vmcnt(7)
    v_mfma_f32_32x32x16_bf16 v[96:111], v[24:27], v[32:35], 0
    s_waitcnt vmcnt(6)
    v_mfma_f32_32x32x16_bf16 v[96:111], v[24:27], v[36:39], v[96:111]
    s_waitcnt vmcnt(5)
    v_mfma_f32_32x32x16_bf16 v[96:111], v[24:27], v[40:43], v[96:111]
    s_waitcnt vmcnt(4)
    v_mfma_f32_32x32x16_bf16 v[96:111], v[24:27], v[44:47], v[96:111]
    s_waitcnt vmcnt(3)
    v_mfma_f32_32x32x16_bf16 v[96:111], v[24:27], v[48:51], v[96:111]
    s_waitcnt vmcnt(2)
    v_mfma_f32_32x32x16_bf16 v[96:111], v[24:27], v[52:55], v[96:111]
    s_waitcnt vmcnt(1)
    v_mfma_f32_32x32x16_bf16 v[96:111], v[24:27], v[56:59], v[96:111]
    s_waitcnt vmcnt(0)
    v_mfma_f32_32x32x16_bf16 v[96:111], v[24:27], v[60:63], v[96:111]
    s_nop 11
    v_cvt_pk_bf16_f32 v28, v96, v97
    v_cvt_pk_bf16_f32 v29, v98, v99
    v_cvt_pk_bf16_f32 v30, v100, v101
    v_cvt_pk_bf16_f32 v31, v102, v103
    s_nop 0
    v_permlane32_swap_b32 v28, v30
    v_permlane32_swap_b32 v29, v31
    s_add_u32 s48, s42, s61
    buffer_store_dwordx4 v[28:31], v13, s[12:15], s48 offen sc1
    s_cmp_ge_u32 s60, 8
    s_cbranch_scc1 L_fb
    s_add_u32 s60, s60, 4
    s_cmp_lt_u32 s60, 8
    s_cbranch_scc1 L_fb2
    s_lshr_b32 s60, s58, 1
    s_add_u32 s60, s60, 8
    s_branch L_fb2
L_done:
L_end1:
    s_endpgm
.section .rodata,"a"
.p2align 6
.amdhsa_kernel concat_heads__gqa_block_cached__mha_block_cached__near_ridge_kernel
  .amdhsa_next_free_vgpr 512
  .amdhsa_next_free_sgpr 102
  .amdhsa_accum_offset 256
  .amdhsa_group_segment_fixed_size 0
  .amdhsa_kernarg_size 104
  .amdhsa_user_sgpr_count 2
  .amdhsa_user_sgpr_kernarg_segment_ptr 1
  .amdhsa_system_sgpr_workgroup_id_x 1
.end_amdhsa_kernel
```
